```python
import torch

def _softmax(x, axis=-1):
    return torch.softmax(x, dim=axis)
def _gelu(x):
    return torch.nn.functional.gelu(x, approximate="tanh")
def _silu(x):
    return torch.nn.functional.silu(x)
def _sigmoid(x):
    return torch.sigmoid(x)
def _layernorm(x, axis=-1, eps=1e-5):
    m = x.mean(dim=axis, keepdim=True)
    v = x.var(dim=axis, keepdim=True, unbiased=False)
    return (x - m) / torch.sqrt(v + eps)
def _scatter_add(tgt, idx, src, axis=0):
    return tgt.clone().index_add_(axis, idx, src)
def _segment_sum(src, seg, n):
    out = torch.zeros((n,) + src.shape[1:], dtype=src.dtype)
    return out.index_add_(0, seg, src)
def _pad(x, pw):
    flat = tuple(v for pair in reversed(pw) for v in pair)
    return torch.nn.functional.pad(x, flat)

kernel_name = 'sequential_preLN__ssm_conv_s4d__glu_gated_reglu__prompt'

def setup_inputs():

    _w = (lambda a: (lambda t: t.to(torch.bfloat16) if t.is_floating_point() else t)(torch.as_tensor(a)))
    def _A_setup():
        Bsz, L, D, N = 1, 2048, 576, 128
        return {
            "u": _w((lambda *s: torch.randn(*s, dtype=torch.bfloat16) * 0.05)(Bsz, L, D)),
            "log_A_real": _w((lambda *s: torch.randn(*s, dtype=torch.bfloat16) * 6.4)(D, N) * 0.5),
            "A_imag": _w((lambda *s: torch.randn(*s, dtype=torch.bfloat16) * 0.05)(D, N) * 3.14),
            "C_real": _w((lambda *s: torch.randn(*s, dtype=torch.bfloat16) * 0.05)(D, N) / N ** 0.5),
            "C_imag": _w((lambda *s: torch.randn(*s, dtype=torch.bfloat16) * 0.05)(D, N) / N ** 0.5),
            "log_dt": _w((lambda *s: torch.randn(*s, dtype=torch.bfloat16) * 0.05)(D) * 0.5 - 4.0),
            "D_skip": _w((lambda *s: torch.randn(*s, dtype=torch.bfloat16) * 0.05)(D)),
        }
    _A_in = _A_setup()

    def _B_setup():
        B, S, D, F = 1, 2048, 576, 4608
        return {
            "x": _w((lambda *s: torch.randn(*s, dtype=torch.bfloat16) * 0.05)(B, S, D)),
            "W_gate": _w((lambda *s: torch.randn(*s, dtype=torch.bfloat16) * 0.4)(D, F) * (2.0 / D) ** 0.5),
            "W_up": _w((lambda *s: torch.randn(*s, dtype=torch.bfloat16) * 0.4)(D, F) * (2.0 / D) ** 0.5),
            "W_down": _w((lambda *s: torch.randn(*s, dtype=torch.bfloat16) * 0.4)(F, D) * (1.0 / F) ** 0.5),
        }
    _B_in = _B_setup()

    return {
        "A_u": _A_in["u"],
        "A_log_A_real": _A_in["log_A_real"],
        "A_A_imag": _A_in["A_imag"],
        "A_C_real": _A_in["C_real"],
        "A_C_imag": _A_in["C_imag"],
        "A_log_dt": _A_in["log_dt"],
        "A_D_skip": _A_in["D_skip"],
        "B_x": _B_in["x"],
        "B_W_gate": _B_in["W_gate"],
        "B_W_up": _B_in["W_up"],
        "B_W_down": _B_in["W_down"],
    }

def reference(A_u, A_log_A_real, A_A_imag, A_C_real, A_C_imag, A_log_dt, A_D_skip, B_x, B_W_gate, B_W_up, B_W_down):
    def _A_ref(u, log_A_real, A_imag, C_real, C_imag, log_dt, D_skip):
        L = u.shape[1]
        dt = torch.exp(log_dt)
        A = -torch.exp(log_A_real) + 1j * A_imag
        C = (C_real + 1j * C_imag) * dt[:, None]
        pos = (lambda x, dt: x.to(dt))(torch.arange(L), log_dt.dtype)
        P = torch.exp((A * dt[:, None])[:, :, None] * pos[None, None, :])
        K = 2.0 * torch.einsum("dn,dnl->dl", C, P).real
        L2 = 2 * L
        u_t = (lambda x, *d: x.permute(*d))(u, 0, 2, 1)
        Kf = (lambda x, *a, **k: torch.fft.rfft(x.float(), *a, **k))(K, L2)
        Uf = (lambda x, *a, **k: torch.fft.rfft(x.float(), *a, **k))(u_t, L2)
        y = (lambda x, *a, **k: torch.fft.irfft(x, *a, **k).to(torch.bfloat16))(Uf * Kf[None, :, :], L2)[:, :, :L]
        y = (lambda x, *d: x.permute(*d))(y, 0, 2, 1)
        return y + u * D_skip[None, None, :]

    def _B_ref(x, W_gate, W_up, W_down):
        gate = torch.einsum("bsd,df->bsf", x, W_gate)
        up = torch.einsum("bsd,df->bsf", x, W_up)
        gate = gate * (lambda x, dt: x.to(dt))(gate > 0, gate.dtype)
        h = gate * up
        return torch.einsum("bsf,fd->bsd", h, W_down)

    x = A_u
    h = x + _A_ref(_layernorm(x, axis=-1), A_log_A_real, A_A_imag, A_C_real, A_C_imag, A_log_dt, A_D_skip)
    h2 = h + _B_ref(_layernorm(h, axis=-1), B_W_gate, B_W_up, B_W_down)
    return h2
```

```asm
; @launch kernel=ka_kernel grid=(256,1,1) block=(512,1,1) lds=150336
; @launch kernel=gemm12_kernel grid=(512,1,1) block=(256,1,1) lds=78592
.amdgcn_target "amdgcn-amd-amdhsa--gfx950"
.text
.globl ka_kernel
.p2align 8
.type ka_kernel,@function
ka_kernel:
  s_cmp_ge_u32 s2, 256
  s_cbranch_scc1 ka_kernel_end
  s_cmp_ge_u32 s2, 144
  s_cbranch_scc1 ka_kernel_aux
  s_load_dwordx2 s[38:39], s[0:1], 0
  s_load_dwordx4 s[4:7], s[0:1], 8
  s_load_dwordx4 s[8:11], s[0:1], 24
  s_load_dwordx4 s[12:15], s[0:1], 40
  s_load_dwordx4 s[16:19], s[0:1], 96
  s_load_dwordx2 s[40:41], s[0:1], 80
  s_getpc_b64 s[20:21]
ka_kernel_pc:
  s_add_u32 s20, s20, ka_kernel_idx-ka_kernel_pc
  s_addc_u32 s21, s21, 0
  v_and_b32 v1, 63, v0
  v_lshrrev_b32 v2, 6, v0
  v_lshrrev_b32 v5, 5, v0
  v_readfirstlane_b32 s3, v2
  v_and_b32 v6, 31, v0
  s_lshl_b32 s34, s2, 4
  v_add_u32 v7, s34, v5
  v_mul_u32_u24 v7, 1152, v7
  v_lshl_add_u32 v7, v6, 4, v7
  v_add_u32 v98, 1024, v7
  v_cmp_gt_u32 vcc, 8, v6
  v_mov_b32 v99, 0x7fffffff
  v_mov_b32 v218, 0
  v_mov_b32 v200, 0
  s_lshr_b32 s23, s3, 1
  s_lshl_b32 s24, s2, 2
  s_add_u32 s24, s24, s23
  s_and_b32 s25, s3, 1
  s_lshl_b32 s25, s25, 6
  s_lshl_b32 s26, s24, 7
  s_add_u32 s26, s26, s25
  s_lshl_b32 s26, s26, 1
  v_cndmask_b32 v98, v99, v98, vcc
  v_lshl_add_u32 v3, v1, 1, s26
  s_lshl_b32 s27, s24, 1
  v_mov_b32 v4, s27
  s_waitcnt lgkmcnt(0)
  s_mov_b32 s28, s38
  s_and_b32 s29, s39, 0xffff
  s_cmp_lt_u32 s2, 128
  s_cselect_b32 s30, 2359296, 0
  s_mov_b32 s31, 0x20000
  buffer_load_dwordx4 v[100:103], v7, s[28:31], 0 offen
  buffer_load_dwordx4 v[104:107], v7, s[28:31], 0 offen offset:512
  buffer_load_dwordx4 v[108:111], v98, s[28:31], 0 offen
  global_load_ushort v26, v3, s[4:5]
  global_load_ushort v27, v3, s[6:7]
  global_load_ushort v28, v3, s[8:9]
  global_load_ushort v29, v3, s[10:11]
  global_load_ushort v30, v4, s[12:13]
  global_load_ushort v240, v4, s[14:15]
  v_and_b32 v3, 255, v0
  v_mul_u32_u24 v3, 24, v3
  global_load_dwordx2 v[8:9], v3, s[20:21] offset:0
  global_load_dwordx2 v[10:11], v3, s[20:21] offset:8
  global_load_dwordx2 v[12:13], v3, s[20:21] offset:16
  v_mov_b32 v233, 0
  global_load_dword v234, v233, s[16:17] sc1
  s_add_u32 s52, s18, 19136512
  s_addc_u32 s53, s19, 0
  s_and_b32 s53, s53, 0xffff
  s_mov_b32 s54, 16384
  s_mov_b32 s55, 0x20000
  s_add_u32 s56, s18, 16777216
  s_addc_u32 s57, s19, 0
  s_and_b32 s57, s57, 0xffff
  s_mov_b32 s58, 2359296
  s_mov_b32 s59, 0x20000
  s_add_u32 s60, s18, 24182784
  s_addc_u32 s61, s19, 0
  s_and_b32 s61, s61, 0xffff
  s_mov_b32 s62, 36864
  s_mov_b32 s63, 0x20000
  s_add_u32 s64, s18, 53477376
  s_addc_u32 s65, s19, 0
  s_and_b32 s65, s65, 0xffff
  s_mov_b32 s66, 4718592
  s_mov_b32 s67, 0x20000
  s_add_u32 s68, s18, 11010048
  s_addc_u32 s69, s19, 0
  s_and_b32 s69, s69, 0xffff
  s_mov_b32 s70, 5308416
  s_mov_b32 s71, 0x20000
  s_mov_b32 s44, s40
  s_and_b32 s45, s41, 0xffff
  s_mov_b32 s46, 5308416
  s_mov_b32 s47, 0x20000
  v_mov_b32 v244, 0
  v_mov_b32 v245, 0
  v_mov_b32 v246, 0
  v_mov_b32 v247, 0
  v_lshlrev_b32 v243, 4, v0
  v_mov_b32 v242, 0x7fffffff
  v_cmp_gt_u32 s[36:37], 16, v0
  s_lshl_b32 s35, s2, 8
  s_nop 0
  v_cndmask_b32 v243, v242, v243, s[36:37]
  buffer_store_dwordx4 v[244:247], v243, s[60:63], s35 offen
  s_cmp_lt_u32 s2, 128
  s_cbranch_scc1 ka_kernel_doln
  s_waitcnt vmcnt(1)
  s_branch ka_kernel_noln
ka_kernel_doln:
  v_mul_u32_u24 v92, 1168, v5
  v_add_u32 v93, 1152, v92
  v_lshl_add_u32 v92, v6, 4, v92
  v_add_u32 v94, 1024, v92
  v_cndmask_b32 v93, v93, v94, vcc
  v_mov_b32 v112, 0
  v_mov_b32 v113, 0
  v_mov_b32 v114, 0
  v_mov_b32 v115, 0
  v_mov_b32 v116, 0x3f803f80
  s_waitcnt vmcnt(13)
  v_dot2c_f32_bf16 v112, v100, v116
  v_dot2c_f32_bf16 v114, v100, v100
  v_dot2c_f32_bf16 v113, v101, v116
  v_dot2c_f32_bf16 v115, v101, v101
  v_dot2c_f32_bf16 v112, v102, v116
  v_dot2c_f32_bf16 v114, v102, v102
  v_dot2c_f32_bf16 v113, v103, v116
  v_dot2c_f32_bf16 v115, v103, v103
  ds_write_b128 v92, v[100:103] offset:0
  s_waitcnt vmcnt(12)
  v_dot2c_f32_bf16 v112, v104, v116
  v_dot2c_f32_bf16 v114, v104, v104
  v_dot2c_f32_bf16 v113, v105, v116
  v_dot2c_f32_bf16 v115, v105, v105
  v_dot2c_f32_bf16 v112, v106, v116
  v_dot2c_f32_bf16 v114, v106, v106
  v_dot2c_f32_bf16 v113, v107, v116
  v_dot2c_f32_bf16 v115, v107, v107
  ds_write_b128 v92, v[104:107] offset:512
  s_waitcnt vmcnt(11)
  v_dot2c_f32_bf16 v112, v108, v116
  v_dot2c_f32_bf16 v114, v108, v108
  v_dot2c_f32_bf16 v113, v109, v116
  v_dot2c_f32_bf16 v115, v109, v109
  v_dot2c_f32_bf16 v112, v110, v116
  v_dot2c_f32_bf16 v114, v110, v110
  v_dot2c_f32_bf16 v113, v111, v116
  v_dot2c_f32_bf16 v115, v111, v111
  ds_write_b128 v93, v[108:111]
  s_nop 1
  v_add_f32 v112, v112, v113
  v_add_f32 v114, v114, v115
  s_nop 1
  v_add_f32_dpp v112, v112, v112 quad_perm:[1,0,3,2] row_mask:0xf bank_mask:0xf
  v_add_f32_dpp v114, v114, v114 quad_perm:[1,0,3,2] row_mask:0xf bank_mask:0xf
  s_nop 1
  v_add_f32_dpp v112, v112, v112 quad_perm:[2,3,0,1] row_mask:0xf bank_mask:0xf
  v_add_f32_dpp v114, v114, v114 quad_perm:[2,3,0,1] row_mask:0xf bank_mask:0xf
  s_nop 1
  v_add_f32_dpp v112, v112, v112 row_half_mirror row_mask:0xf bank_mask:0xf
  v_add_f32_dpp v114, v114, v114 row_half_mirror row_mask:0xf bank_mask:0xf
  s_nop 1
  v_add_f32_dpp v112, v112, v112 row_mirror row_mask:0xf bank_mask:0xf
  v_add_f32_dpp v114, v114, v114 row_mirror row_mask:0xf bank_mask:0xf
  ds_swizzle_b32 v113, v112 offset:0x401F
  ds_swizzle_b32 v115, v114 offset:0x401F
  s_mov_b32 s34, 0x3ae38e39
  s_waitcnt lgkmcnt(0)
  v_add_f32 v112, v112, v113
  v_add_f32 v114, v114, v115
  v_mul_f32 v112, s34, v112
  v_mul_f32 v114, s34, v114
  v_fma_f32 v114, -v112, v112, v114
  v_max_f32 v114, 0, v114
  v_cvt_pk_bf16_f32 v114, v114, v114
  v_and_b32 v114, 0xffff0000, v114
  v_add_f32 v114, 0x3727c5ac, v114
  v_cvt_pk_bf16_f32 v114, v114, v114
  v_and_b32 v114, 0xffff0000, v114
  v_sqrt_f32 v114, v114
  s_nop 0
  v_cvt_pk_bf16_f32 v112, v112, v114
  v_lshlrev_b32 v113, 2, v5
  v_add_u32 v113, 18688, v113
  v_cmp_eq_u32 vcc, 0, v6
  s_and_saveexec_b64 s[34:35], vcc
  ds_write_b32 v113, v112
  s_mov_b64 exec, s[34:35]
  v_bfe_u32 v3, v1, 2, 2
  v_and_b32 v4, 3, v1
  v_and_b32 v5, 1, v4
  v_lshl_add_u32 v5, v5, 3, v3
  v_mul_u32_u24 v5, 1168, v5
  v_lshrrev_b32 v6, 4, v1
  v_lshl_add_u32 v5, v6, 4, v5
  v_lshrrev_b32 v7, 1, v4
  v_lshl_add_u32 v5, v7, 3, v5
  s_lshl_b32 s34, s3, 6
  v_add_u32 v5, s34, v5
  v_lshrrev_b32 v7, 1, v3
  v_lshl_add_u32 v7, v6, 1, v7
  v_lshlrev_b32 v7, 15, v7
  v_and_b32 v3, 1, v3
  v_lshl_add_u32 v7, v3, 6, v7
  v_lshl_add_u32 v218, v4, 4, v7
  s_lshl_b32 s51, s3, 18
  s_lshl_b32 s35, s2, 8
  s_add_u32 s51, s51, s35
  s_waitcnt lgkmcnt(0)
  s_barrier
  ds_read_b64_tr_b16 v[204:205], v5 offset:0
  ds_read_b64_tr_b16 v[206:207], v5 offset:4672
  ds_read_b64_tr_b16 v[208:209], v5 offset:512
  ds_read_b64_tr_b16 v[210:211], v5 offset:5184
  s_cmp_ge_u32 s3, 2
  s_cbranch_scc1 ka_kernel_p2
  ds_read_b64_tr_b16 v[212:213], v5 offset:1024
  ds_read_b64_tr_b16 v[214:215], v5 offset:5696
ka_kernel_p2:
  v_lshlrev_b32 v113, 2, v1
  v_add_u32 v113, 18688, v113
  ds_read_b32 v216, v113
  s_waitcnt lgkmcnt(0) vmcnt(1)
  s_barrier
ka_kernel_noln:
  s_cmp_ge_u32 s2, 128
  s_cbranch_scc1 ka_kernel_nopubx
  s_mov_b32 s33, 40000
ka_kernel_nsp0:
  v_readfirstlane_b32 s50, v234
  s_cmp_lg_u32 s50, 0
  s_cbranch_scc1 ka_kernel_nok0
  s_sleep 2
  global_load_dword v234, v233, s[16:17] sc1
  s_waitcnt vmcnt(0)
  s_sub_u32 s33, s33, 1
  s_cmp_lg_u32 s33, 0
  s_cbranch_scc1 ka_kernel_nsp0
ka_kernel_nok0:
  s_cmp_lg_u32 s3, 0
  s_cbranch_scc1 ka_kernel_nost
  v_mov_b32 v217, s50
  v_lshlrev_b32 v113, 3, v1
  v_mov_b32 v112, 0x7fffffff
  v_cmp_gt_u32 vcc, 16, v1
  s_lshl_b32 s35, s2, 7
  s_nop 0
  v_cndmask_b32 v113, v112, v113, vcc
  buffer_store_dwordx2 v[216:217], v113, s[52:55], s35 offen sc1
ka_kernel_nost:
  v_mov_b32 v120, v204
  v_mov_b32 v121, s50
  v_mov_b32 v122, v205
  v_mov_b32 v123, s50
  v_mov_b32 v124, v206
  v_mov_b32 v125, s50
  v_mov_b32 v126, v207
  v_mov_b32 v127, s50
  s_add_u32 s35, s51, 0
  buffer_store_dwordx4 v[120:123], v218, s[64:67], s35 offen sc1
  buffer_store_dwordx4 v[124:127], v218, s[64:67], s35 offen offset:128 sc1
  v_mov_b32 v128, v208
  v_mov_b32 v129, s50
  v_mov_b32 v130, v209
  v_mov_b32 v131, s50
  v_mov_b32 v132, v210
  v_mov_b32 v133, s50
  v_mov_b32 v134, v211
  v_mov_b32 v135, s50
  s_add_u32 s35, s51, 2097152
  buffer_store_dwordx4 v[128:131], v218, s[64:67], s35 offen sc1
  buffer_store_dwordx4 v[132:135], v218, s[64:67], s35 offen offset:128 sc1
  s_cmp_ge_u32 s3, 2
  s_cbranch_scc1 ka_kernel_p3
  v_mov_b32 v120, v212
  v_mov_b32 v121, s50
  v_mov_b32 v122, v213
  v_mov_b32 v123, s50
  v_mov_b32 v124, v214
  v_mov_b32 v125, s50
  v_mov_b32 v126, v215
  v_mov_b32 v127, s50
  s_add_u32 s35, s51, 4194304
  buffer_store_dwordx4 v[120:123], v218, s[64:67], s35 offen sc1
  buffer_store_dwordx4 v[124:127], v218, s[64:67], s35 offen offset:128 sc1
ka_kernel_p3:
ka_kernel_nopubx:
  v_lshlrev_b32 v26, 16, v26
  v_lshlrev_b32 v27, 16, v27
  v_lshlrev_b32 v28, 16, v28
  v_lshlrev_b32 v29, 16, v29
  v_lshlrev_b32 v30, 16, v30
  v_mul_f32 v26, 0x3fb8aa3b, v26
  v_mul_f32 v30, 0x3fb8aa3b, v30
  v_exp_f32 v26, v26
  v_exp_f32 v30, v30
  s_nop 0
  v_cvt_pk_bf16_f32 v26, v26, v26
  v_and_b32 v26, 0xffff0000, v26
  v_cvt_pk_bf16_f32 v30, v30, v30
  v_and_b32 v30, 0xffff0000, v30
  v_mul_f32 v44, v26, v30
  v_mul_f32 v45, v27, v30
  v_mul_f32 v44, 0xbfb8aa3b, v44
  v_mul_f32 v45, 0x3e22f983, v45
  v_add_f32 v30, v30, v30
  v_mul_f32 v46, v28, v30
  v_mul_f32 v47, v29, v30
  v_exp_f32 v68, v44
  v_fract_f32 v69, v45
  v_cos_f32 v48, v69
  v_sin_f32 v49, v69
  s_nop 0
  v_mul_f32 v48, v48, v68
  v_mul_f32 v49, v49, v68
  v_ldexp_f32 v70, v44, 3
  v_ldexp_f32 v71, v45, 3
  v_exp_f32 v70, v70
  v_fract_f32 v71, v71
  v_cos_f32 v62, v71
  v_sin_f32 v63, v71
  s_nop 0
  v_mul_f32 v62, v62, v70
  v_mul_f32 v63, v63, v70
  v_ldexp_f32 v72, v44, 7
  v_ldexp_f32 v73, v45, 7
  v_exp_f32 v72, v72
  v_fract_f32 v73, v73
  v_cos_f32 v66, v73
  v_sin_f32 v67, v73
  s_nop 0
  v_mul_f32 v66, v66, v72
  v_mul_f32 v67, v67, v72
  s_mul_i32 s28, s23, 31008
  s_lshl_b32 s29, s25, 2
  s_add_u32 s28, s28, s29
  v_lshl_add_u32 v3, v1, 2, s28
  v_pk_mul_f32 v[68:69], v[48:49], v[48:49] op_sel:[0,0] op_sel_hi:[0,1]
  v_pk_fma_f32 v[50:51], v[48:49], v[48:49], v[68:69] op_sel:[1,1,0] op_sel_hi:[1,0,1] neg_lo:[0,1,0]
  v_pk_mul_f32 v[70:71], v[62:63], v[62:63] op_sel:[0,0] op_sel_hi:[0,1]
  v_pk_fma_f32 v[64:65], v[62:63], v[62:63], v[70:71] op_sel:[1,1,0] op_sel_hi:[1,0,1] neg_lo:[0,1,0]
  v_pk_mul_f32 v[68:69], v[50:51], v[48:49] op_sel:[0,0] op_sel_hi:[0,1]
  v_pk_fma_f32 v[52:53], v[50:51], v[48:49], v[68:69] op_sel:[1,1,0] op_sel_hi:[1,0,1] neg_lo:[0,1,0]
  v_pk_mul_f32 v[70:71], v[50:51], v[50:51] op_sel:[0,0] op_sel_hi:[0,1]
  v_pk_fma_f32 v[54:55], v[50:51], v[50:51], v[70:71] op_sel:[1,1,0] op_sel_hi:[1,0,1] neg_lo:[0,1,0]
  v_pk_mul_f32 v[68:69], v[54:55], v[48:49] op_sel:[0,0] op_sel_hi:[0,1]
  v_pk_fma_f32 v[56:57], v[54:55], v[48:49], v[68:69] op_sel:[1,1,0] op_sel_hi:[1,0,1] neg_lo:[0,1,0]
  v_pk_mul_f32 v[70:71], v[54:55], v[50:51] op_sel:[0,0] op_sel_hi:[0,1]
  v_pk_fma_f32 v[58:59], v[54:55], v[50:51], v[70:71] op_sel:[1,1,0] op_sel_hi:[1,0,1] neg_lo:[0,1,0]
  v_pk_mul_f32 v[72:73], v[54:55], v[52:53] op_sel:[0,0] op_sel_hi:[0,1]
  v_pk_fma_f32 v[60:61], v[54:55], v[52:53], v[72:73] op_sel:[1,1,0] op_sel_hi:[1,0,1] neg_lo:[0,1,0]
  v_mov_b32 v76, 1.0
  v_mov_b32 v77, 0
  v_cvt_pk_bf16_f32 v80, v76, v77
  ds_write_b32 v3, v80 offset:22304
  v_cvt_pk_bf16_f32 v81, v62, v63
  ds_write_b32 v3, v81 offset:22848
  v_mov_b32 v78, v62
  v_mov_b32 v79, v63
  v_pk_mul_f32 v[68:69], v[76:77], v[64:65] op_sel:[0,0] op_sel_hi:[0,1]
  v_pk_fma_f32 v[76:77], v[76:77], v[64:65], v[68:69] op_sel:[1,1,0] op_sel_hi:[1,0,1] neg_lo:[0,1,0]
  v_cvt_pk_bf16_f32 v82, v76, v77
  ds_write_b32 v3, v82 offset:23392
  v_cvt_pk_bf16_f32 v83, v46, -v47
  ds_write_b32 v3, v83 offset:0
  v_pk_mul_f32 v[72:73], v[46:47], v[48:49] op_sel:[0,0] op_sel_hi:[0,1]
  v_pk_fma_f32 v[88:89], v[46:47], v[48:49], v[72:73] op_sel:[1,1,0] op_sel_hi:[1,0,1] neg_lo:[0,1,0]
  v_cvt_pk_bf16_f32 v84, v88, -v89
  ds_write_b32 v3, v84 offset:544
  v_pk_mul_f32 v[74:75], v[46:47], v[50:51] op_sel:[0,0] op_sel_hi:[0,1]
  v_pk_fma_f32 v[90:91], v[46:47], v[50:51], v[74:75] op_sel:[1,1,0] op_sel_hi:[1,0,1] neg_lo:[0,1,0]
  v_cvt_pk_bf16_f32 v85, v90, -v91
  ds_write_b32 v3, v85 offset:1088
  v_pk_mul_f32 v[72:73], v[46:47], v[52:53] op_sel:[0,0] op_sel_hi:[0,1]
  v_pk_fma_f32 v[92:93], v[46:47], v[52:53], v[72:73] op_sel:[1,1,0] op_sel_hi:[1,0,1] neg_lo:[0,1,0]
  v_cvt_pk_bf16_f32 v86, v92, -v93
  ds_write_b32 v3, v86 offset:1632
  v_pk_mul_f32 v[68:69], v[78:79], v[64:65] op_sel:[0,0] op_sel_hi:[0,1]
  v_pk_fma_f32 v[78:79], v[78:79], v[64:65], v[68:69] op_sel:[1,1,0] op_sel_hi:[1,0,1] neg_lo:[0,1,0]
  v_cvt_pk_bf16_f32 v87, v78, v79
  ds_write_b32 v3, v87 offset:23936
  v_pk_mul_f32 v[74:75], v[46:47], v[54:55] op_sel:[0,0] op_sel_hi:[0,1]
  v_pk_fma_f32 v[94:95], v[46:47], v[54:55], v[74:75] op_sel:[1,1,0] op_sel_hi:[1,0,1] neg_lo:[0,1,0]
  v_cvt_pk_bf16_f32 v80, v94, -v95
  ds_write_b32 v3, v80 offset:2176
  v_pk_mul_f32 v[72:73], v[46:47], v[56:57] op_sel:[0,0] op_sel_hi:[0,1]
  v_pk_fma_f32 v[88:89], v[46:47], v[56:57], v[72:73] op_sel:[1,1,0] op_sel_hi:[1,0,1] neg_lo:[0,1,0]
  v_cvt_pk_bf16_f32 v81, v88, -v89
  ds_write_b32 v3, v81 offset:2720
  v_pk_mul_f32 v[74:75], v[46:47], v[58:59] op_sel:[0,0] op_sel_hi:[0,1]
  v_pk_fma_f32 v[90:91], v[46:47], v[58:59], v[74:75] op_sel:[1,1,0] op_sel_hi:[1,0,1] neg_lo:[0,1,0]
  v_cvt_pk_bf16_f32 v82, v90, -v91
  ds_write_b32 v3, v82 offset:3264
  v_pk_mul_f32 v[72:73], v[46:47], v[60:61] op_sel:[0,0] op_sel_hi:[0,1]
  v_pk_fma_f32 v[92:93], v[46:47], v[60:61], v[72:73] op_sel:[1,1,0] op_sel_hi:[1,0,1] neg_lo:[0,1,0]
  v_cvt_pk_bf16_f32 v83, v92, -v93
  ds_write_b32 v3, v83 offset:3808
  v_pk_mul_f32 v[68:69], v[76:77], v[64:65] op_sel:[0,0] op_sel_hi:[0,1]
  v_pk_fma_f32 v[76:77], v[76:77], v[64:65], v[68:69] op_sel:[1,1,0] op_sel_hi:[1,0,1] neg_lo:[0,1,0]
  v_cvt_pk_bf16_f32 v84, v76, v77
  ds_write_b32 v3, v84 offset:24480
  v_pk_mul_f32 v[70:71], v[46:47], v[66:67] op_sel:[0,0] op_sel_hi:[0,1]
  v_pk_fma_f32 v[46:47], v[46:47], v[66:67], v[70:71] op_sel:[1,1,0] op_sel_hi:[1,0,1] neg_lo:[0,1,0]
  v_cvt_pk_bf16_f32 v85, v46, -v47
  ds_write_b32 v3, v85 offset:4352
  v_pk_mul_f32 v[74:75], v[46:47], v[48:49] op_sel:[0,0] op_sel_hi:[0,1]
  v_pk_fma_f32 v[94:95], v[46:47], v[48:49], v[74:75] op_sel:[1,1,0] op_sel_hi:[1,0,1] neg_lo:[0,1,0]
  v_cvt_pk_bf16_f32 v86, v94, -v95
  ds_write_b32 v3, v86 offset:4896
  v_pk_mul_f32 v[72:73], v[46:47], v[50:51] op_sel:[0,0] op_sel_hi:[0,1]
  v_pk_fma_f32 v[88:89], v[46:47], v[50:51], v[72:73] op_sel:[1,1,0] op_sel_hi:[1,0,1] neg_lo:[0,1,0]
  v_cvt_pk_bf16_f32 v87, v88, -v89
  ds_write_b32 v3, v87 offset:5440
  v_pk_mul_f32 v[68:69], v[78:79], v[64:65] op_sel:[0,0] op_sel_hi:[0,1]
  v_pk_fma_f32 v[78:79], v[78:79], v[64:65], v[68:69] op_sel:[1,1,0] op_sel_hi:[1,0,1] neg_lo:[0,1,0]
  v_cvt_pk_bf16_f32 v80, v78, v79
  ds_write_b32 v3, v80 offset:25024
  v_pk_mul_f32 v[74:75], v[46:47], v[52:53] op_sel:[0,0] op_sel_hi:[0,1]
  v_pk_fma_f32 v[90:91], v[46:47], v[52:53], v[74:75] op_sel:[1,1,0] op_sel_hi:[1,0,1] neg_lo:[0,1,0]
  v_cvt_pk_bf16_f32 v81, v90, -v91
  ds_write_b32 v3, v81 offset:5984
  v_pk_mul_f32 v[72:73], v[46:47], v[54:55] op_sel:[0,0] op_sel_hi:[0,1]
  v_pk_fma_f32 v[92:93], v[46:47], v[54:55], v[72:73] op_sel:[1,1,0] op_sel_hi:[1,0,1] neg_lo:[0,1,0]
  v_cvt_pk_bf16_f32 v82, v92, -v93
  ds_write_b32 v3, v82 offset:6528
  v_pk_mul_f32 v[74:75], v[46:47], v[56:57] op_sel:[0,0] op_sel_hi:[0,1]
  v_pk_fma_f32 v[94:95], v[46:47], v[56:57], v[74:75] op_sel:[1,1,0] op_sel_hi:[1,0,1] neg_lo:[0,1,0]
  v_cvt_pk_bf16_f32 v83, v94, -v95
  ds_write_b32 v3, v83 offset:7072
  v_pk_mul_f32 v[72:73], v[46:47], v[58:59] op_sel:[0,0] op_sel_hi:[0,1]
  v_pk_fma_f32 v[88:89], v[46:47], v[58:59], v[72:73] op_sel:[1,1,0] op_sel_hi:[1,0,1] neg_lo:[0,1,0]
  v_cvt_pk_bf16_f32 v84, v88, -v89
  ds_write_b32 v3, v84 offset:7616
  v_pk_mul_f32 v[68:69], v[76:77], v[64:65] op_sel:[0,0] op_sel_hi:[0,1]
  v_pk_fma_f32 v[76:77], v[76:77], v[64:65], v[68:69] op_sel:[1,1,0] op_sel_hi:[1,0,1] neg_lo:[0,1,0]
  v_cvt_pk_bf16_f32 v85, v76, v77
  ds_write_b32 v3, v85 offset:25568
  v_pk_mul_f32 v[74:75], v[46:47], v[60:61] op_sel:[0,0] op_sel_hi:[0,1]
  v_pk_fma_f32 v[90:91], v[46:47], v[60:61], v[74:75] op_sel:[1,1,0] op_sel_hi:[1,0,1] neg_lo:[0,1,0]
  v_cvt_pk_bf16_f32 v86, v90, -v91
  ds_write_b32 v3, v86 offset:8160
  v_pk_mul_f32 v[70:71], v[46:47], v[66:67] op_sel:[0,0] op_sel_hi:[0,1]
  v_pk_fma_f32 v[46:47], v[46:47], v[66:67], v[70:71] op_sel:[1,1,0] op_sel_hi:[1,0,1] neg_lo:[0,1,0]
  v_cvt_pk_bf16_f32 v87, v46, -v47
  ds_write_b32 v3, v87 offset:8704
  v_pk_mul_f32 v[72:73], v[46:47], v[50:51] op_sel:[0,0] op_sel_hi:[0,1]
  v_pk_fma_f32 v[92:93], v[46:47], v[50:51], v[72:73] op_sel:[1,1,0] op_sel_hi:[1,0,1] neg_lo:[0,1,0]
  v_cvt_pk_bf16_f32 v80, v92, -v93
  ds_write_b32 v3, v80 offset:9248
  v_pk_mul_f32 v[68:69], v[78:79], v[64:65] op_sel:[0,0] op_sel_hi:[0,1]
  v_pk_fma_f32 v[78:79], v[78:79], v[64:65], v[68:69] op_sel:[1,1,0] op_sel_hi:[1,0,1] neg_lo:[0,1,0]
  v_cvt_pk_bf16_f32 v81, v78, v79
  ds_write_b32 v3, v81 offset:26112
  v_pk_mul_f32 v[74:75], v[46:47], v[54:55] op_sel:[0,0] op_sel_hi:[0,1]
  v_pk_fma_f32 v[94:95], v[46:47], v[54:55], v[74:75] op_sel:[1,1,0] op_sel_hi:[1,0,1] neg_lo:[0,1,0]
  v_cvt_pk_bf16_f32 v82, v94, -v95
  ds_write_b32 v3, v82 offset:9792
  v_pk_mul_f32 v[72:73], v[46:47], v[58:59] op_sel:[0,0] op_sel_hi:[0,1]
  v_pk_fma_f32 v[88:89], v[46:47], v[58:59], v[72:73] op_sel:[1,1,0] op_sel_hi:[1,0,1] neg_lo:[0,1,0]
  v_cvt_pk_bf16_f32 v83, v88, -v89
  ds_write_b32 v3, v83 offset:10336
  v_pk_mul_f32 v[70:71], v[46:47], v[66:67] op_sel:[0,0] op_sel_hi:[0,1]
  v_pk_fma_f32 v[46:47], v[46:47], v[66:67], v[70:71] op_sel:[1,1,0] op_sel_hi:[1,0,1] neg_lo:[0,1,0]
  v_cvt_pk_bf16_f32 v84, v46, -v47
  ds_write_b32 v3, v84 offset:10880
  v_pk_mul_f32 v[68:69], v[76:77], v[64:65] op_sel:[0,0] op_sel_hi:[0,1]
  v_pk_fma_f32 v[76:77], v[76:77], v[64:65], v[68:69] op_sel:[1,1,0] op_sel_hi:[1,0,1] neg_lo:[0,1,0]
  v_cvt_pk_bf16_f32 v85, v76, v77
  ds_write_b32 v3, v85 offset:26656
  v_pk_mul_f32 v[74:75], v[46:47], v[50:51] op_sel:[0,0] op_sel_hi:[0,1]
  v_pk_fma_f32 v[90:91], v[46:47], v[50:51], v[74:75] op_sel:[1,1,0] op_sel_hi:[1,0,1] neg_lo:[0,1,0]
  v_cvt_pk_bf16_f32 v86, v90, -v91
  ds_write_b32 v3, v86 offset:11424
  v_pk_mul_f32 v[72:73], v[46:47], v[54:55] op_sel:[0,0] op_sel_hi:[0,1]
  v_pk_fma_f32 v[92:93], v[46:47], v[54:55], v[72:73] op_sel:[1,1,0] op_sel_hi:[1,0,1] neg_lo:[0,1,0]
  v_cvt_pk_bf16_f32 v87, v92, -v93
  ds_write_b32 v3, v87 offset:11968
  v_pk_mul_f32 v[74:75], v[46:47], v[58:59] op_sel:[0,0] op_sel_hi:[0,1]
  v_pk_fma_f32 v[94:95], v[46:47], v[58:59], v[74:75] op_sel:[1,1,0] op_sel_hi:[1,0,1] neg_lo:[0,1,0]
  v_cvt_pk_bf16_f32 v80, v94, -v95
  ds_write_b32 v3, v80 offset:12512
  v_pk_mul_f32 v[70:71], v[46:47], v[66:67] op_sel:[0,0] op_sel_hi:[0,1]
  v_pk_fma_f32 v[46:47], v[46:47], v[66:67], v[70:71] op_sel:[1,1,0] op_sel_hi:[1,0,1] neg_lo:[0,1,0]
  v_pk_mul_f32 v[68:69], v[78:79], v[64:65] op_sel:[0,0] op_sel_hi:[0,1]
  v_pk_fma_f32 v[78:79], v[78:79], v[64:65], v[68:69] op_sel:[1,1,0] op_sel_hi:[1,0,1] neg_lo:[0,1,0]
  v_cvt_pk_bf16_f32 v81, v78, v79
  ds_write_b32 v3, v81 offset:27200
  v_cvt_pk_bf16_f32 v82, v46, -v47
  ds_write_b32 v3, v82 offset:13056
  v_pk_mul_f32 v[72:73], v[46:47], v[54:55] op_sel:[0,0] op_sel_hi:[0,1]
  v_pk_fma_f32 v[88:89], v[46:47], v[54:55], v[72:73] op_sel:[1,1,0] op_sel_hi:[1,0,1] neg_lo:[0,1,0]
  v_cvt_pk_bf16_f32 v83, v88, -v89
  ds_write_b32 v3, v83 offset:13600
  v_pk_mul_f32 v[70:71], v[46:47], v[66:67] op_sel:[0,0] op_sel_hi:[0,1]
  v_pk_fma_f32 v[46:47], v[46:47], v[66:67], v[70:71] op_sel:[1,1,0] op_sel_hi:[1,0,1] neg_lo:[0,1,0]
  v_cvt_pk_bf16_f32 v84, v46, -v47
  ds_write_b32 v3, v84 offset:14144
  v_pk_mul_f32 v[68:69], v[76:77], v[64:65] op_sel:[0,0] op_sel_hi:[0,1]
  v_pk_fma_f32 v[76:77], v[76:77], v[64:65], v[68:69] op_sel:[1,1,0] op_sel_hi:[1,0,1] neg_lo:[0,1,0]
  v_cvt_pk_bf16_f32 v85, v76, v77
  ds_write_b32 v3, v85 offset:27744
  v_pk_mul_f32 v[74:75], v[46:47], v[54:55] op_sel:[0,0] op_sel_hi:[0,1]
  v_pk_fma_f32 v[90:91], v[46:47], v[54:55], v[74:75] op_sel:[1,1,0] op_sel_hi:[1,0,1] neg_lo:[0,1,0]
  v_cvt_pk_bf16_f32 v86, v90, -v91
  ds_write_b32 v3, v86 offset:14688
  v_pk_mul_f32 v[70:71], v[46:47], v[66:67] op_sel:[0,0] op_sel_hi:[0,1]
  v_pk_fma_f32 v[46:47], v[46:47], v[66:67], v[70:71] op_sel:[1,1,0] op_sel_hi:[1,0,1] neg_lo:[0,1,0]
  v_cvt_pk_bf16_f32 v87, v46, -v47
  ds_write_b32 v3, v87 offset:15232
  v_pk_mul_f32 v[72:73], v[46:47], v[54:55] op_sel:[0,0] op_sel_hi:[0,1]
  v_pk_fma_f32 v[92:93], v[46:47], v[54:55], v[72:73] op_sel:[1,1,0] op_sel_hi:[1,0,1] neg_lo:[0,1,0]
  v_cvt_pk_bf16_f32 v80, v92, -v93
  ds_write_b32 v3, v80 offset:15776
  v_pk_mul_f32 v[68:69], v[78:79], v[64:65] op_sel:[0,0] op_sel_hi:[0,1]
  v_pk_fma_f32 v[78:79], v[78:79], v[64:65], v[68:69] op_sel:[1,1,0] op_sel_hi:[1,0,1] neg_lo:[0,1,0]
  v_cvt_pk_bf16_f32 v81, v78, v79
  ds_write_b32 v3, v81 offset:28288
  v_pk_mul_f32 v[70:71], v[46:47], v[66:67] op_sel:[0,0] op_sel_hi:[0,1]
  v_pk_fma_f32 v[46:47], v[46:47], v[66:67], v[70:71] op_sel:[1,1,0] op_sel_hi:[1,0,1] neg_lo:[0,1,0]
  v_cvt_pk_bf16_f32 v82, v46, -v47
  ds_write_b32 v3, v82 offset:16320
  v_pk_mul_f32 v[74:75], v[46:47], v[54:55] op_sel:[0,0] op_sel_hi:[0,1]
  v_pk_fma_f32 v[94:95], v[46:47], v[54:55], v[74:75] op_sel:[1,1,0] op_sel_hi:[1,0,1] neg_lo:[0,1,0]
  v_cvt_pk_bf16_f32 v83, v94, -v95
  ds_write_b32 v3, v83 offset:16864
  v_pk_mul_f32 v[70:71], v[46:47], v[66:67] op_sel:[0,0] op_sel_hi:[0,1]
  v_pk_fma_f32 v[46:47], v[46:47], v[66:67], v[70:71] op_sel:[1,1,0] op_sel_hi:[1,0,1] neg_lo:[0,1,0]
  v_pk_mul_f32 v[68:69], v[76:77], v[64:65] op_sel:[0,0] op_sel_hi:[0,1]
  v_pk_fma_f32 v[76:77], v[76:77], v[64:65], v[68:69] op_sel:[1,1,0] op_sel_hi:[1,0,1] neg_lo:[0,1,0]
  v_cvt_pk_bf16_f32 v84, v76, v77
  ds_write_b32 v3, v84 offset:28832
  v_cvt_pk_bf16_f32 v85, v46, -v47
  ds_write_b32 v3, v85 offset:17408
  v_pk_mul_f32 v[70:71], v[46:47], v[66:67] op_sel:[0,0] op_sel_hi:[0,1]
  v_pk_fma_f32 v[46:47], v[46:47], v[66:67], v[70:71] op_sel:[1,1,0] op_sel_hi:[1,0,1] neg_lo:[0,1,0]
  v_cvt_pk_bf16_f32 v86, v46, -v47
  ds_write_b32 v3, v86 offset:17952
  v_pk_mul_f32 v[70:71], v[46:47], v[66:67] op_sel:[0,0] op_sel_hi:[0,1]
  v_pk_fma_f32 v[46:47], v[46:47], v[66:67], v[70:71] op_sel:[1,1,0] op_sel_hi:[1,0,1] neg_lo:[0,1,0]
  v_pk_mul_f32 v[68:69], v[78:79], v[64:65] op_sel:[0,0] op_sel_hi:[0,1]
  v_pk_fma_f32 v[78:79], v[78:79], v[64:65], v[68:69] op_sel:[1,1,0] op_sel_hi:[1,0,1] neg_lo:[0,1,0]
  v_cvt_pk_bf16_f32 v87, v78, v79
  ds_write_b32 v3, v87 offset:29376
  v_cvt_pk_bf16_f32 v80, v46, -v47
  ds_write_b32 v3, v80 offset:18496
  v_pk_mul_f32 v[70:71], v[46:47], v[66:67] op_sel:[0,0] op_sel_hi:[0,1]
  v_pk_fma_f32 v[46:47], v[46:47], v[66:67], v[70:71] op_sel:[1,1,0] op_sel_hi:[1,0,1] neg_lo:[0,1,0]
  v_cvt_pk_bf16_f32 v81, v46, -v47
  ds_write_b32 v3, v81 offset:19040
  v_pk_mul_f32 v[70:71], v[46:47], v[66:67] op_sel:[0,0] op_sel_hi:[0,1]
  v_pk_fma_f32 v[46:47], v[46:47], v[66:67], v[70:71] op_sel:[1,1,0] op_sel_hi:[1,0,1] neg_lo:[0,1,0]
  v_pk_mul_f32 v[68:69], v[76:77], v[64:65] op_sel:[0,0] op_sel_hi:[0,1]
  v_pk_fma_f32 v[76:77], v[76:77], v[64:65], v[68:69] op_sel:[1,1,0] op_sel_hi:[1,0,1] neg_lo:[0,1,0]
  v_cvt_pk_bf16_f32 v82, v76, v77
  ds_write_b32 v3, v82 offset:29920
  v_cvt_pk_bf16_f32 v83, v46, -v47
  ds_write_b32 v3, v83 offset:19584
  v_pk_mul_f32 v[70:71], v[46:47], v[66:67] op_sel:[0,0] op_sel_hi:[0,1]
  v_pk_fma_f32 v[46:47], v[46:47], v[66:67], v[70:71] op_sel:[1,1,0] op_sel_hi:[1,0,1] neg_lo:[0,1,0]
  v_cvt_pk_bf16_f32 v84, v46, -v47
  ds_write_b32 v3, v84 offset:20128
  v_pk_mul_f32 v[70:71], v[46:47], v[66:67] op_sel:[0,0] op_sel_hi:[0,1]
  v_pk_fma_f32 v[46:47], v[46:47], v[66:67], v[70:71] op_sel:[1,1,0] op_sel_hi:[1,0,1] neg_lo:[0,1,0]
  v_pk_mul_f32 v[68:69], v[78:79], v[64:65] op_sel:[0,0] op_sel_hi:[0,1]
  v_pk_fma_f32 v[78:79], v[78:79], v[64:65], v[68:69] op_sel:[1,1,0] op_sel_hi:[1,0,1] neg_lo:[0,1,0]
  v_cvt_pk_bf16_f32 v85, v78, v79
  ds_write_b32 v3, v85 offset:30464
  v_cvt_pk_bf16_f32 v86, v46, -v47
  ds_write_b32 v3, v86 offset:20672
  v_pk_mul_f32 v[70:71], v[46:47], v[66:67] op_sel:[0,0] op_sel_hi:[0,1]
  v_pk_fma_f32 v[46:47], v[46:47], v[66:67], v[70:71] op_sel:[1,1,0] op_sel_hi:[1,0,1] neg_lo:[0,1,0]
  v_cvt_pk_bf16_f32 v87, v46, -v47
  ds_write_b32 v3, v87 offset:21216
  v_pk_mul_f32 v[70:71], v[46:47], v[66:67] op_sel:[0,0] op_sel_hi:[0,1]
  v_pk_fma_f32 v[46:47], v[46:47], v[66:67], v[70:71] op_sel:[1,1,0] op_sel_hi:[1,0,1] neg_lo:[0,1,0]
  v_cvt_pk_bf16_f32 v80, v46, -v47
  ds_write_b32 v3, v80 offset:21760
  v_and_b32 v14, 0xffff, v8
  v_lshrrev_b32 v15, 16, v8
  v_and_b32 v16, 0xffff, v9
  v_lshrrev_b32 v17, 16, v9
  v_and_b32 v18, 0xffff, v10
  v_lshrrev_b32 v19, 16, v10
  v_and_b32 v20, 0xffff, v11
  v_lshrrev_b32 v21, 16, v11
  v_and_b32 v22, 0xffff, v12
  v_lshrrev_b32 v23, 16, v12
  v_and_b32 v24, 0xffff, v13
  v_lshrrev_b32 v25, 16, v13
  v_and_b32 v3, 15, v1
  v_lshrrev_b32 v4, 4, v1
  v_mul_u32_u24 v5, 544, v3
  v_lshl_add_u32 v5, v4, 4, v5
  v_lshlrev_b32 v6, 7, v4
  v_lshl_add_u32 v6, v3, 1, v6
  s_mul_i32 s28, s23, 31008
  s_add_u32 s29, s28, 22304
  v_add_u32 v96, s29, v5
  s_and_b32 s30, s3, 1
  s_mul_i32 s31, s30, 17408
  s_add_u32 s28, s28, s31
  v_add_u32 v7, s28, v5
  s_mul_i32 s31, s23, 1552
  s_lshl_b32 s32, s30, 10
  s_add_u32 s31, s31, s32
  s_add_u32 s31, s31, 124032
  v_add_u32 v6, s31, v6
  s_waitcnt lgkmcnt(0)
  s_barrier
  ds_read_b128 v[100:103], v7 offset:0
  ds_read_b128 v[132:135], v96 offset:0
  ds_read_b128 v[104:107], v7 offset:64
  ds_read_b128 v[136:139], v96 offset:64
  ds_read_b128 v[108:111], v7 offset:128
  ds_read_b128 v[140:143], v96 offset:128
  ds_read_b128 v[112:115], v7 offset:192
  ds_read_b128 v[144:147], v96 offset:192
  ds_read_b128 v[116:119], v7 offset:256
  ds_read_b128 v[148:151], v96 offset:256
  ds_read_b128 v[120:123], v7 offset:320
  ds_read_b128 v[152:155], v96 offset:320
  ds_read_b128 v[124:127], v7 offset:384
  ds_read_b128 v[156:159], v96 offset:384
  ds_read_b128 v[128:131], v7 offset:448
  ds_read_b128 v[160:163], v96 offset:448
  s_cmp_eq_u32 s30, 1
  s_cbranch_scc1 ka_kernel_kodd
  ds_read_b128 v[172:175], v7 offset:8704
  ds_read_b128 v[176:179], v7 offset:8768
  ds_read_b128 v[180:183], v7 offset:8832
  ds_read_b128 v[184:187], v7 offset:8896
  ds_read_b128 v[188:191], v7 offset:8960
  ds_read_b128 v[192:195], v7 offset:9024
  ds_read_b128 v[196:199], v7 offset:9088
  ds_read_b128 v[200:203], v7 offset:9152
  s_waitcnt lgkmcnt(0)
  v_mfma_f32_16x16x32_bf16 v[168:171], v[172:175], v[132:135], 0
  v_mfma_f32_16x16x32_bf16 v[168:171], v[176:179], v[136:139], v[168:171]
  v_mfma_f32_16x16x32_bf16 v[168:171], v[180:183], v[140:143], v[168:171]
  v_mfma_f32_16x16x32_bf16 v[168:171], v[184:187], v[144:147], v[168:171]
  v_mfma_f32_16x16x32_bf16 v[168:171], v[188:191], v[148:151], v[168:171]
  v_mfma_f32_16x16x32_bf16 v[168:171], v[192:195], v[152:155], v[168:171]
  v_mfma_f32_16x16x32_bf16 v[168:171], v[196:199], v[156:159], v[168:171]
  v_mfma_f32_16x16x32_bf16 v[168:171], v[200:203], v[160:163], v[168:171]
  s_nop 7
  v_cvt_pk_bf16_f32 v168, v168, v169
  v_cvt_pk_bf16_f32 v169, v170, v171
  ds_write_b16 v6, v168 offset:512
  ds_write_b16_d16_hi v6, v168 offset:544
  ds_write_b16 v6, v169 offset:576
  ds_write_b16_d16_hi v6, v169 offset:608
ka_kernel_kodd:
  s_waitcnt lgkmcnt(0)
  v_mfma_f32_16x16x32_bf16 v[164:167], v[100:103], v[132:135], 0
  v_mfma_f32_16x16x32_bf16 v[164:167], v[104:107], v[136:139], v[164:167]
  v_mfma_f32_16x16x32_bf16 v[164:167], v[108:111], v[140:143], v[164:167]
  v_mfma_f32_16x16x32_bf16 v[164:167], v[112:115], v[144:147], v[164:167]
  v_mfma_f32_16x16x32_bf16 v[164:167], v[116:119], v[148:151], v[164:167]
  v_mfma_f32_16x16x32_bf16 v[164:167], v[120:123], v[152:155], v[164:167]
  v_mfma_f32_16x16x32_bf16 v[164:167], v[124:127], v[156:159], v[164:167]
  v_mfma_f32_16x16x32_bf16 v[164:167], v[128:131], v[160:163], v[164:167]
  v_mul_u32_u24 v7, 1552, v0
  v_add_u32 v7, 125568, v7
  v_mov_b32 v96, 0
  v_cmp_gt_u32 vcc, 4, v0
  s_nop 3
  v_cvt_pk_bf16_f32 v164, v164, v165
  v_cvt_pk_bf16_f32 v165, v166, v167
  ds_write_b16 v6, v164
  ds_write_b16_d16_hi v6, v164 offset:32
  ds_write_b16 v6, v165 offset:64
  ds_write_b16_d16_hi v6, v165 offset:96
  s_and_saveexec_b64 s[28:29], vcc
  ds_write_b32 v7, v96
  s_mov_b64 exec, s[28:29]
  s_waitcnt lgkmcnt(0)
  s_barrier
  s_mov_b32 s33, 40000
ka_kernel_nsp1:
  v_readfirstlane_b32 s50, v234
  s_cmp_lg_u32 s50, 0
  s_cbranch_scc1 ka_kernel_nok1
  s_sleep 2
  global_load_dword v234, v233, s[16:17] sc1
  s_waitcnt vmcnt(0)
  s_sub_u32 s33, s33, 1
  s_cmp_lg_u32 s33, 0
  s_cbranch_scc1 ka_kernel_nsp1
ka_kernel_nok1:
  v_lshrrev_b32 v3, 4, v0
  v_bfe_u32 v4, v0, 2, 1
  v_bfe_u32 v5, v0, 3, 1
  v_lshlrev_b32 v6, 4, v3
  v_lshl_add_u32 v6, v4, 3, v6
  v_lshl_add_u32 v6, v5, 2, v6
  v_lshlrev_b32 v220, 3, v6
  v_and_b32 v7, 3, v0
  v_mul_u32_u24 v221, 4112, v7
  v_lshl_add_u32 v221, v6, 1, v221
  v_add_u32 v221, 96960, v221
  v_mul_u32_u24 v222, 7600, v7
  v_lshrrev_b32 v4, 5, v6
  v_mul_u32_u24 v4, 80, v4
  v_add_u32 v222, v222, v4
  v_and_b32 v4, 31, v6
  v_lshl_add_u32 v222, v4, 1, v222
  v_add_u32 v222, 69040, v222
  v_lshlrev_b32 v223, 4, v0
  s_lshl_b32 s36, s2, 15
  s_add_u32 s31, s36, 0
  buffer_load_dwordx4 v[160:163], v223, s[64:67], s31 offen sc1
  s_movk_i32 s31, 0
  buffer_load_dwordx4 v[176:179], v220, s[52:55], s31 offen sc1
  buffer_load_dwordx4 v[180:183], v220, s[52:55], s31 offen offset:16 sc1
  s_add_u32 s31, s36, 8192
  buffer_load_dwordx4 v[164:167], v223, s[64:67], s31 offen sc1
  s_movk_i32 s31, 4096
  buffer_load_dwordx4 v[184:187], v220, s[52:55], s31 offen sc1
  buffer_load_dwordx4 v[188:191], v220, s[52:55], s31 offen offset:16 sc1
  s_add_u32 s31, s36, 16384
  buffer_load_dwordx4 v[168:171], v223, s[64:67], s31 offen sc1
  s_movk_i32 s31, 8192
  buffer_load_dwordx4 v[192:195], v220, s[52:55], s31 offen sc1
  buffer_load_dwordx4 v[196:199], v220, s[52:55], s31 offen offset:16 sc1
  s_add_u32 s31, s36, 24576
  buffer_load_dwordx4 v[172:175], v223, s[64:67], s31 offen sc1
  s_movk_i32 s31, 12288
  buffer_load_dwordx4 v[200:203], v220, s[52:55], s31 offen sc1
  buffer_load_dwordx4 v[204:207], v220, s[52:55], s31 offen offset:16 sc1
  v_lshrrev_b32 v3, 8, v0
  v_and_b32 v4, 255, v0
  v_mul_u32_u24 v5, 1552, v3
  v_add_u32 v5, 124032, v5
  v_add_u32 v14, v5, v14
  v_add_u32 v15, v5, v15
  v_add_u32 v16, v5, v16
  v_add_u32 v17, v5, v17
  v_add_u32 v18, v5, v18
  v_add_u32 v19, v5, v19
  v_add_u32 v20, v5, v20
  v_add_u32 v21, v5, v21
  v_add_u32 v22, v5, v22
  v_add_u32 v23, v5, v23
  v_add_u32 v24, v5, v24
  v_add_u32 v25, v5, v25
  v_mul_u32_u24 v6, 16640, v3
  v_lshl_add_u32 v6, v4, 4, v6
  s_mov_b32 s28, 0xffff0000
  ds_read_u16 v100, v14 offset:0
  ds_read_u16_d16_hi v144, v15 offset:0
  ds_read_u16 v101, v16 offset:0
  ds_read_u16_d16_hi v145, v17 offset:0
  ds_read_u16 v102, v18 offset:0
  ds_read_u16_d16_hi v146, v19 offset:0
  ds_read_u16 v103, v20 offset:0
  ds_read_u16_d16_hi v147, v21 offset:0
  ds_read_u16 v104, v22 offset:0
  ds_read_u16_d16_hi v148, v23 offset:0
  ds_read_u16 v105, v24 offset:0
  ds_read_u16_d16_hi v149, v25 offset:0
  ds_read_u16 v116, v14 offset:3104
  ds_read_u16_d16_hi v152, v15 offset:3104
  ds_read_u16 v117, v16 offset:3104
  ds_read_u16_d16_hi v153, v17 offset:3104
  ds_read_u16 v118, v18 offset:3104
  ds_read_u16_d16_hi v154, v19 offset:3104
  ds_read_u16 v119, v20 offset:3104
  ds_read_u16_d16_hi v155, v21 offset:3104
  ds_read_u16 v120, v22 offset:3104
  ds_read_u16_d16_hi v156, v23 offset:3104
  ds_read_u16 v121, v24 offset:3104
  ds_read_u16_d16_hi v157, v25 offset:3104
  v_mov_b32 v140, 0
  v_mov_b32 v141, 0
  v_mov_b32 v142, 0
  v_mov_b32 v143, 0
  s_waitcnt lgkmcnt(12)
  v_and_or_b32 v100, v144, s28, v100
  v_and_or_b32 v101, v145, s28, v101
  v_and_or_b32 v102, v146, s28, v102
  v_and_or_b32 v103, v147, s28, v103
  v_and_or_b32 v104, v148, s28, v104
  v_and_or_b32 v105, v149, s28, v105
  v_alignbit_b32 v48, v101, v100, 16
  v_alignbit_b32 v49, v102, v101, 16
  v_alignbit_b32 v50, v103, v102, 16
  v_alignbit_b32 v51, v104, v103, 16
  v_alignbit_b32 v52, v102, v101, 16
  v_alignbit_b32 v53, v103, v102, 16
  v_alignbit_b32 v54, v104, v103, 16
  v_alignbit_b32 v55, v105, v104, 16
  v_mov_b32 v56, v101
  v_mov_b32 v57, v102
  v_mov_b32 v58, v103
  v_mov_b32 v59, v104
  ds_write_b128 v6, v[100:103] offset:0
  ds_write_b128 v6, v[48:51] offset:4160
  ds_write_b128 v6, v[56:59] offset:8320
  ds_write_b128 v6, v[52:55] offset:12480
  s_waitcnt lgkmcnt(4)
  v_and_or_b32 v116, v152, s28, v116
  v_and_or_b32 v117, v153, s28, v117
  v_and_or_b32 v118, v154, s28, v118
  v_and_or_b32 v119, v155, s28, v119
  v_and_or_b32 v120, v156, s28, v120
  v_and_or_b32 v121, v157, s28, v121
  v_alignbit_b32 v60, v117, v116, 16
  v_alignbit_b32 v61, v118, v117, 16
  v_alignbit_b32 v62, v119, v118, 16
  v_alignbit_b32 v63, v120, v119, 16
  v_alignbit_b32 v64, v118, v117, 16
  v_alignbit_b32 v65, v119, v118, 16
  v_alignbit_b32 v66, v120, v119, 16
  v_alignbit_b32 v67, v121, v120, 16
  v_mov_b32 v68, v117
  v_mov_b32 v69, v118
  v_mov_b32 v70, v119
  v_mov_b32 v71, v120
  ds_write_b128 v6, v[116:119] offset:33280
  ds_write_b128 v6, v[60:63] offset:37440
  ds_write_b128 v6, v[68:71] offset:41600
  ds_write_b128 v6, v[64:67] offset:45760
  v_lshrrev_b32 v3, 2, v0
  v_mul_u32_u24 v3, 4160, v3
  v_and_b32 v4, 3, v0
  v_lshl_add_u32 v3, v4, 4, v3
  v_add_u32 v3, 4096, v3
  v_cmp_gt_u32 vcc, 64, v0
  s_and_saveexec_b64 s[28:29], vcc
  ds_write_b128 v3, v[140:143]
  s_mov_b64 exec, s[28:29]
  v_lshlrev_b32 v3, 4, v0
  v_add_u32 v3, 66560, v3
  v_cmp_gt_u32 vcc, 155, v0
  s_and_saveexec_b64 s[28:29], vcc
  ds_write_b128 v3, v[140:143] offset:0
  ds_write_b128 v3, v[140:143] offset:7600
  ds_write_b128 v3, v[140:143] offset:15200
  ds_write_b128 v3, v[140:143] offset:22800
  s_mov_b64 exec, s[28:29]
  s_mov_b32 s33, 40000
ka_kernel_upoll:
  s_waitcnt vmcnt(0)
  v_xor_b32 v224, s50, v161
  v_xor_b32 v225, s50, v163
  v_or_b32 v224, v224, v225
  v_xor_b32 v225, s50, v165
  v_or_b32 v224, v224, v225
  v_xor_b32 v225, s50, v167
  v_or_b32 v224, v224, v225
  v_xor_b32 v225, s50, v169
  v_or_b32 v224, v224, v225
  v_xor_b32 v225, s50, v171
  v_or_b32 v224, v224, v225
  v_xor_b32 v225, s50, v173
  v_or_b32 v224, v224, v225
  v_xor_b32 v225, s50, v175
  v_or_b32 v224, v224, v225
  v_xor_b32 v225, s50, v177
  v_or_b32 v224, v224, v225
  v_xor_b32 v225, s50, v179
  v_or_b32 v224, v224, v225
  v_xor_b32 v225, s50, v181
  v_or_b32 v224, v224, v225
  v_xor_b32 v225, s50, v183
  v_or_b32 v224, v224, v225
  v_xor_b32 v225, s50, v185
  v_or_b32 v224, v224, v225
  v_xor_b32 v225, s50, v187
  v_or_b32 v224, v224, v225
  v_xor_b32 v225, s50, v189
  v_or_b32 v224, v224, v225
  v_xor_b32 v225, s50, v191
  v_or_b32 v224, v224, v225
  v_xor_b32 v225, s50, v193
  v_or_b32 v224, v224, v225
  v_xor_b32 v225, s50, v195
  v_or_b32 v224, v224, v225
  v_xor_b32 v225, s50, v197
  v_or_b32 v224, v224, v225
  v_xor_b32 v225, s50, v199
  v_or_b32 v224, v224, v225
  v_xor_b32 v225, s50, v201
  v_or_b32 v224, v224, v225
  v_xor_b32 v225, s50, v203
  v_or_b32 v224, v224, v225
  v_xor_b32 v225, s50, v205
  v_or_b32 v224, v224, v225
  v_xor_b32 v225, s50, v207
  v_or_b32 v224, v224, v225
  v_cmp_eq_u32 vcc, 0, v224
  s_cmp_eq_u64 vcc, -1
  s_cbranch_scc1 ka_kernel_uok
  s_sleep 4
  s_add_u32 s31, s36, 0
  buffer_load_dwordx4 v[160:163], v223, s[64:67], s31 offen sc1
  s_movk_i32 s31, 0
  buffer_load_dwordx4 v[176:179], v220, s[52:55], s31 offen sc1
  buffer_load_dwordx4 v[180:183], v220, s[52:55], s31 offen offset:16 sc1
  s_add_u32 s31, s36, 8192
  buffer_load_dwordx4 v[164:167], v223, s[64:67], s31 offen sc1
  s_movk_i32 s31, 4096
  buffer_load_dwordx4 v[184:187], v220, s[52:55], s31 offen sc1
  buffer_load_dwordx4 v[188:191], v220, s[52:55], s31 offen offset:16 sc1
  s_add_u32 s31, s36, 16384
  buffer_load_dwordx4 v[168:171], v223, s[64:67], s31 offen sc1
  s_movk_i32 s31, 8192
  buffer_load_dwordx4 v[192:195], v220, s[52:55], s31 offen sc1
  buffer_load_dwordx4 v[196:199], v220, s[52:55], s31 offen offset:16 sc1
  s_add_u32 s31, s36, 24576
  buffer_load_dwordx4 v[172:175], v223, s[64:67], s31 offen sc1
  s_movk_i32 s31, 12288
  buffer_load_dwordx4 v[200:203], v220, s[52:55], s31 offen sc1
  buffer_load_dwordx4 v[204:207], v220, s[52:55], s31 offen offset:16 sc1
  s_sub_u32 s33, s33, 1
  s_cmp_lg_u32 s33, 0
  s_cbranch_scc1 ka_kernel_upoll
ka_kernel_uok:
  ds_write2_b32 v221, v160, v162 offset0:0 offset1:1
  v_lshlrev_b32 v100, 16, v160
  v_and_b32 v101, 0xffff0000, v160
  v_lshlrev_b32 v102, 16, v162
  v_and_b32 v103, 0xffff0000, v162
  v_and_b32 v108, 0xffff0000, v176
  v_lshlrev_b32 v104, 16, v176
  v_rcp_f32 v108, v108
  v_and_b32 v109, 0xffff0000, v178
  v_lshlrev_b32 v105, 16, v178
  v_rcp_f32 v109, v109
  v_and_b32 v110, 0xffff0000, v180
  v_lshlrev_b32 v106, 16, v180
  v_rcp_f32 v110, v110
  v_and_b32 v111, 0xffff0000, v182
  v_lshlrev_b32 v107, 16, v182
  v_rcp_f32 v111, v111
  v_pk_add_f32 v[100:101], v[100:101], v[104:105] neg_lo:[0,1] neg_hi:[0,1]
  v_pk_add_f32 v[102:103], v[102:103], v[106:107] neg_lo:[0,1] neg_hi:[0,1]
  v_cvt_pk_bf16_f32 v112, v100, v101
  v_cvt_pk_bf16_f32 v113, v102, v103
  v_lshlrev_b32 v100, 16, v112
  v_and_b32 v101, 0xffff0000, v112
  v_lshlrev_b32 v102, 16, v113
  v_and_b32 v103, 0xffff0000, v113
  v_pk_mul_f32 v[100:101], v[100:101], v[108:109]
  v_pk_mul_f32 v[102:103], v[102:103], v[110:111]
  v_cvt_pk_bf16_f32 v112, v100, v101
  v_cvt_pk_bf16_f32 v113, v102, v103
  ds_write_b64 v222, v[112:113]
  v_add_u32 v4, 1024, v221
  ds_write2_b32 v4, v164, v166 offset0:0 offset1:1
  v_lshlrev_b32 v116, 16, v164
  v_and_b32 v117, 0xffff0000, v164
  v_lshlrev_b32 v118, 16, v166
  v_and_b32 v119, 0xffff0000, v166
  v_and_b32 v124, 0xffff0000, v184
  v_lshlrev_b32 v120, 16, v184
  v_rcp_f32 v124, v124
  v_and_b32 v125, 0xffff0000, v186
  v_lshlrev_b32 v121, 16, v186
  v_rcp_f32 v125, v125
  v_and_b32 v126, 0xffff0000, v188
  v_lshlrev_b32 v122, 16, v188
  v_rcp_f32 v126, v126
  v_and_b32 v127, 0xffff0000, v190
  v_lshlrev_b32 v123, 16, v190
  v_rcp_f32 v127, v127
  v_pk_add_f32 v[116:117], v[116:117], v[120:121] neg_lo:[0,1] neg_hi:[0,1]
  v_pk_add_f32 v[118:119], v[118:119], v[122:123] neg_lo:[0,1] neg_hi:[0,1]
  v_cvt_pk_bf16_f32 v128, v116, v117
  v_cvt_pk_bf16_f32 v129, v118, v119
  v_lshlrev_b32 v116, 16, v128
  v_and_b32 v117, 0xffff0000, v128
  v_lshlrev_b32 v118, 16, v129
  v_and_b32 v119, 0xffff0000, v129
  v_pk_mul_f32 v[116:117], v[116:117], v[124:125]
  v_pk_mul_f32 v[118:119], v[118:119], v[126:127]
  v_cvt_pk_bf16_f32 v128, v116, v117
  v_cvt_pk_bf16_f32 v129, v118, v119
  ds_write_b64 v222, v[128:129] offset:1280
  v_add_u32 v4, 2048, v221
  ds_write2_b32 v4, v168, v170 offset0:0 offset1:1
  v_lshlrev_b32 v100, 16, v168
  v_and_b32 v101, 0xffff0000, v168
  v_lshlrev_b32 v102, 16, v170
  v_and_b32 v103, 0xffff0000, v170
  v_and_b32 v108, 0xffff0000, v192
  v_lshlrev_b32 v104, 16, v192
  v_rcp_f32 v108, v108
  v_and_b32 v109, 0xffff0000, v194
  v_lshlrev_b32 v105, 16, v194
  v_rcp_f32 v109, v109
  v_and_b32 v110, 0xffff0000, v196
  v_lshlrev_b32 v106, 16, v196
  v_rcp_f32 v110, v110
  v_and_b32 v111, 0xffff0000, v198
  v_lshlrev_b32 v107, 16, v198
  v_rcp_f32 v111, v111
  v_pk_add_f32 v[100:101], v[100:101], v[104:105] neg_lo:[0,1] neg_hi:[0,1]
  v_pk_add_f32 v[102:103], v[102:103], v[106:107] neg_lo:[0,1] neg_hi:[0,1]
  v_cvt_pk_bf16_f32 v112, v100, v101
  v_cvt_pk_bf16_f32 v113, v102, v103
  v_lshlrev_b32 v100, 16, v112
  v_and_b32 v101, 0xffff0000, v112
  v_lshlrev_b32 v102, 16, v113
  v_and_b32 v103, 0xffff0000, v113
  v_pk_mul_f32 v[100:101], v[100:101], v[108:109]
  v_pk_mul_f32 v[102:103], v[102:103], v[110:111]
  v_cvt_pk_bf16_f32 v112, v100, v101
  v_cvt_pk_bf16_f32 v113, v102, v103
  ds_write_b64 v222, v[112:113] offset:2560
  v_add_u32 v4, 3072, v221
  ds_write2_b32 v4, v172, v174 offset0:0 offset1:1
  v_lshlrev_b32 v116, 16, v172
  v_and_b32 v117, 0xffff0000, v172
  v_lshlrev_b32 v118, 16, v174
  v_and_b32 v119, 0xffff0000, v174
  v_and_b32 v124, 0xffff0000, v200
  v_lshlrev_b32 v120, 16, v200
  v_rcp_f32 v124, v124
  v_and_b32 v125, 0xffff0000, v202
  v_lshlrev_b32 v121, 16, v202
  v_rcp_f32 v125, v125
  v_and_b32 v126, 0xffff0000, v204
  v_lshlrev_b32 v122, 16, v204
  v_rcp_f32 v126, v126
  v_and_b32 v127, 0xffff0000, v206
  v_lshlrev_b32 v123, 16, v206
  v_rcp_f32 v127, v127
  v_pk_add_f32 v[116:117], v[116:117], v[120:121] neg_lo:[0,1] neg_hi:[0,1]
  v_pk_add_f32 v[118:119], v[118:119], v[122:123] neg_lo:[0,1] neg_hi:[0,1]
  v_cvt_pk_bf16_f32 v128, v116, v117
  v_cvt_pk_bf16_f32 v129, v118, v119
  v_lshlrev_b32 v116, 16, v128
  v_and_b32 v117, 0xffff0000, v128
  v_lshlrev_b32 v118, 16, v129
  v_and_b32 v119, 0xffff0000, v129
  v_pk_mul_f32 v[116:117], v[116:117], v[124:125]
  v_pk_mul_f32 v[118:119], v[118:119], v[126:127]
  v_cvt_pk_bf16_f32 v128, v116, v117
  v_cvt_pk_bf16_f32 v129, v118, v119
  ds_write_b64 v222, v[128:129] offset:3840
  v_and_b32 v3, 31, v1
  v_lshrrev_b32 v4, 5, v1
  v_and_b32 v10, 3, v3
  v_sub_u32 v10, 3, v10
  v_mul_u32_u24 v10, 4160, v10
  v_and_b32 v11, 28, v3
  v_lshlrev_b32 v11, 1, v11
  v_sub_u32 v10, v10, v11
  v_lshl_add_u32 v10, v4, 4, v10
  s_mul_i32 s32, s3, 16640
  s_add_u32 s32, s32, 56
  v_add_u32 v8, s32, v10
  v_mul_u32_u24 v10, 80, v3
  v_lshl_add_u32 v10, v4, 4, v10
  s_mul_i32 s32, s3, 7600
  s_add_u32 s32, s32, 66560
  v_add_u32 v9, s32, v10
  v_mov_b32 v16, 0
  v_mov_b32 v17, 0
  v_mov_b32 v18, 0
  v_mov_b32 v19, 0
  v_mov_b32 v20, 0
  v_mov_b32 v21, 0
  v_mov_b32 v22, 0
  v_mov_b32 v23, 0
  v_mov_b32 v24, 0
  v_mov_b32 v25, 0
  v_mov_b32 v26, 0
  v_mov_b32 v27, 0
  v_mov_b32 v28, 0
  v_mov_b32 v29, 0
  v_mov_b32 v30, 0
  v_mov_b32 v31, 0
  v_mov_b32 v32, 0
  v_mov_b32 v33, 0
  v_mov_b32 v34, 0
  v_mov_b32 v35, 0
  v_mov_b32 v36, 0
  v_mov_b32 v37, 0
  v_mov_b32 v38, 0
  v_mov_b32 v39, 0
  v_mov_b32 v40, 0
  v_mov_b32 v41, 0
  v_mov_b32 v42, 0
  v_mov_b32 v43, 0
  v_mov_b32 v44, 0
  v_mov_b32 v45, 0
  v_mov_b32 v46, 0
  v_mov_b32 v47, 0
  v_mov_b32 v112, 0
  v_mov_b32 v113, 0
  v_mov_b32 v114, 0
  v_mov_b32 v115, 0
  v_mov_b32 v116, 0
  v_mov_b32 v117, 0
  v_mov_b32 v118, 0
  v_mov_b32 v119, 0
  v_mov_b32 v120, 0
  v_mov_b32 v121, 0
  v_mov_b32 v122, 0
  v_mov_b32 v123, 0
  v_mov_b32 v124, 0
  v_mov_b32 v125, 0
  v_mov_b32 v126, 0
  v_mov_b32 v127, 0
  s_waitcnt lgkmcnt(0)
  s_barrier
  s_cmp_ge_u32 s3, 4
  s_cbranch_scc1 ka_kernel_xload
  ds_read_b64 v[48:49], v8 offset:4032
  ds_read_b64 v[50:51], v8 offset:4040
  ds_read_b128 v[56:59], v9 offset:2480
  ds_read_b128 v[60:63], v9 offset:5040
  ds_read_b64 v[52:53], v8 offset:1984
  ds_read_b64 v[54:55], v8 offset:1992
  ds_read_b64 v[64:65], v8 offset:4064
  ds_read_b64 v[66:67], v8 offset:4072
  ds_read_b128 v[72:75], v9 offset:2512
  ds_read_b128 v[76:79], v9 offset:5072
  ds_read_b64 v[68:69], v8 offset:2016
  ds_read_b64 v[70:71], v8 offset:2024
  s_mov_b32 s32, 0
ka_kernel_cl:
  s_waitcnt lgkmcnt(6)
  v_mfma_f32_32x32x16_bf16 v[16:31], v[48:51], v[56:59], v[16:31]
  ds_read_b64 v[80:81], v8 offset:3968
  ds_read_b64 v[82:83], v8 offset:3976
  v_mfma_f32_32x32x16_bf16 v[32:47], v[48:51], v[60:63], v[32:47]
  ds_read_b128 v[88:91], v9 offset:2400
  ds_read_b128 v[92:95], v9 offset:4960
  v_mfma_f32_32x32x16_bf16 v[112:127], v[52:55], v[56:59], v[112:127]
  ds_read_b64 v[84:85], v8 offset:1920
  ds_read_b64 v[86:87], v8 offset:1928
  s_waitcnt lgkmcnt(6)
  v_mfma_f32_32x32x16_bf16 v[16:31], v[64:67], v[72:75], v[16:31]
  ds_read_b64 v[96:97], v8 offset:4000
  ds_read_b64 v[98:99], v8 offset:4008
  v_mfma_f32_32x32x16_bf16 v[32:47], v[64:67], v[76:79], v[32:47]
  ds_read_b128 v[104:107], v9 offset:2432
  ds_read_b128 v[108:111], v9 offset:4992
  v_mfma_f32_32x32x16_bf16 v[112:127], v[68:71], v[72:75], v[112:127]
  ds_read_b64 v[100:101], v8 offset:1952
  ds_read_b64 v[102:103], v8 offset:1960
  s_waitcnt lgkmcnt(6)
  v_mfma_f32_32x32x16_bf16 v[16:31], v[80:83], v[88:91], v[16:31]
  ds_read_b64 v[48:49], v8 offset:3904
  ds_read_b64 v[50:51], v8 offset:3912
  v_mfma_f32_32x32x16_bf16 v[32:47], v[80:83], v[92:95], v[32:47]
  ds_read_b128 v[56:59], v9 offset:2320
  ds_read_b128 v[60:63], v9 offset:4880
  v_mfma_f32_32x32x16_bf16 v[112:127], v[84:87], v[88:91], v[112:127]
  ds_read_b64 v[52:53], v8 offset:1856
  ds_read_b64 v[54:55], v8 offset:1864
  s_waitcnt lgkmcnt(6)
  v_mfma_f32_32x32x16_bf16 v[16:31], v[96:99], v[104:107], v[16:31]
  ds_read_b64 v[64:65], v8 offset:3936
  ds_read_b64 v[66:67], v8 offset:3944
  v_mfma_f32_32x32x16_bf16 v[32:47], v[96:99], v[108:111], v[32:47]
  ds_read_b128 v[72:75], v9 offset:2352
  ds_read_b128 v[76:79], v9 offset:4912
  v_mfma_f32_32x32x16_bf16 v[112:127], v[100:103], v[104:107], v[112:127]
  ds_read_b64 v[68:69], v8 offset:1888
  ds_read_b64 v[70:71], v8 offset:1896
  s_waitcnt lgkmcnt(6)
  v_mfma_f32_32x32x16_bf16 v[16:31], v[48:51], v[56:59], v[16:31]
  ds_read_b64 v[80:81], v8 offset:3840
  ds_read_b64 v[82:83], v8 offset:3848
  v_mfma_f32_32x32x16_bf16 v[32:47], v[48:51], v[60:63], v[32:47]
  ds_read_b128 v[88:91], v9 offset:2240
  ds_read_b128 v[92:95], v9 offset:4800
  v_mfma_f32_32x32x16_bf16 v[112:127], v[52:55], v[56:59], v[112:127]
  ds_read_b64 v[84:85], v8 offset:1792
  ds_read_b64 v[86:87], v8 offset:1800
  s_waitcnt lgkmcnt(6)
  v_mfma_f32_32x32x16_bf16 v[16:31], v[64:67], v[72:75], v[16:31]
  ds_read_b64 v[96:97], v8 offset:3872
  ds_read_b64 v[98:99], v8 offset:3880
  v_mfma_f32_32x32x16_bf16 v[32:47], v[64:67], v[76:79], v[32:47]
  ds_read_b128 v[104:107], v9 offset:2272
  ds_read_b128 v[108:111], v9 offset:4832
  v_mfma_f32_32x32x16_bf16 v[112:127], v[68:71], v[72:75], v[112:127]
  ds_read_b64 v[100:101], v8 offset:1824
  ds_read_b64 v[102:103], v8 offset:1832
  s_waitcnt lgkmcnt(6)
  v_mfma_f32_32x32x16_bf16 v[16:31], v[80:83], v[88:91], v[16:31]
  ds_read_b64 v[48:49], v8 offset:3776
  ds_read_b64 v[50:51], v8 offset:3784
  v_mfma_f32_32x32x16_bf16 v[32:47], v[80:83], v[92:95], v[32:47]
  ds_read_b128 v[56:59], v9 offset:2160
  ds_read_b128 v[60:63], v9 offset:4720
  v_mfma_f32_32x32x16_bf16 v[112:127], v[84:87], v[88:91], v[112:127]
  ds_read_b64 v[52:53], v8 offset:1728
  ds_read_b64 v[54:55], v8 offset:1736
  s_waitcnt lgkmcnt(6)
  v_mfma_f32_32x32x16_bf16 v[16:31], v[96:99], v[104:107], v[16:31]
  ds_read_b64 v[64:65], v8 offset:3808
  ds_read_b64 v[66:67], v8 offset:3816
  v_mfma_f32_32x32x16_bf16 v[32:47], v[96:99], v[108:111], v[32:47]
  ds_read_b128 v[72:75], v9 offset:2192
  ds_read_b128 v[76:79], v9 offset:4752
  v_mfma_f32_32x32x16_bf16 v[112:127], v[100:103], v[104:107], v[112:127]
  ds_read_b64 v[68:69], v8 offset:1760
  ds_read_b64 v[70:71], v8 offset:1768
  v_subrev_u32 v8, 256, v8
  v_subrev_u32 v9, 320, v9
  s_add_u32 s32, s32, 1
  s_cmp_lt_u32 s32, 7
  s_cbranch_scc1 ka_kernel_cl
  s_waitcnt lgkmcnt(6)
  v_mfma_f32_32x32x16_bf16 v[16:31], v[48:51], v[56:59], v[16:31]
  ds_read_b64 v[80:81], v8 offset:3968
  ds_read_b64 v[82:83], v8 offset:3976
  v_mfma_f32_32x32x16_bf16 v[32:47], v[48:51], v[60:63], v[32:47]
  ds_read_b128 v[88:91], v9 offset:2400
  ds_read_b128 v[92:95], v9 offset:4960
  v_mfma_f32_32x32x16_bf16 v[112:127], v[52:55], v[56:59], v[112:127]
  ds_read_b64 v[84:85], v8 offset:1920
  ds_read_b64 v[86:87], v8 offset:1928
  s_waitcnt lgkmcnt(6)
  v_mfma_f32_32x32x16_bf16 v[16:31], v[64:67], v[72:75], v[16:31]
  ds_read_b64 v[96:97], v8 offset:4000
  ds_read_b64 v[98:99], v8 offset:4008
  v_mfma_f32_32x32x16_bf16 v[32:47], v[64:67], v[76:79], v[32:47]
  ds_read_b128 v[104:107], v9 offset:2432
  ds_read_b128 v[108:111], v9 offset:4992
  v_mfma_f32_32x32x16_bf16 v[112:127], v[68:71], v[72:75], v[112:127]
  ds_read_b64 v[100:101], v8 offset:1952
  ds_read_b64 v[102:103], v8 offset:1960
  s_waitcnt lgkmcnt(6)
  v_mfma_f32_32x32x16_bf16 v[16:31], v[80:83], v[88:91], v[16:31]
  ds_read_b64 v[48:49], v8 offset:3904
  ds_read_b64 v[50:51], v8 offset:3912
  v_mfma_f32_32x32x16_bf16 v[32:47], v[80:83], v[92:95], v[32:47]
  ds_read_b128 v[56:59], v9 offset:2320
  ds_read_b128 v[60:63], v9 offset:4880
  v_mfma_f32_32x32x16_bf16 v[112:127], v[84:87], v[88:91], v[112:127]
  ds_read_b64 v[52:53], v8 offset:1856
  ds_read_b64 v[54:55], v8 offset:1864
  s_waitcnt lgkmcnt(6)
  v_mfma_f32_32x32x16_bf16 v[16:31], v[96:99], v[104:107], v[16:31]
  ds_read_b64 v[64:65], v8 offset:3936
  ds_read_b64 v[66:67], v8 offset:3944
  v_mfma_f32_32x32x16_bf16 v[32:47], v[96:99], v[108:111], v[32:47]
  ds_read_b128 v[72:75], v9 offset:2352
  ds_read_b128 v[76:79], v9 offset:4912
  v_mfma_f32_32x32x16_bf16 v[112:127], v[100:103], v[104:107], v[112:127]
  ds_read_b64 v[68:69], v8 offset:1888
  ds_read_b64 v[70:71], v8 offset:1896
  s_waitcnt lgkmcnt(6)
  v_mfma_f32_32x32x16_bf16 v[16:31], v[48:51], v[56:59], v[16:31]
  ds_read_b64 v[80:81], v8 offset:3840
  ds_read_b64 v[82:83], v8 offset:3848
  v_mfma_f32_32x32x16_bf16 v[32:47], v[48:51], v[60:63], v[32:47]
  ds_read_b128 v[88:91], v9 offset:2240
  ds_read_b128 v[92:95], v9 offset:4800
  v_mfma_f32_32x32x16_bf16 v[112:127], v[52:55], v[56:59], v[112:127]
  ds_read_b64 v[84:85], v8 offset:1792
  ds_read_b64 v[86:87], v8 offset:1800
  s_waitcnt lgkmcnt(6)
  v_mfma_f32_32x32x16_bf16 v[16:31], v[64:67], v[72:75], v[16:31]
  ds_read_b64 v[96:97], v8 offset:3872
  ds_read_b64 v[98:99], v8 offset:3880
  v_mfma_f32_32x32x16_bf16 v[32:47], v[64:67], v[76:79], v[32:47]
  ds_read_b128 v[104:107], v9 offset:2272
  ds_read_b128 v[108:111], v9 offset:4832
  v_mfma_f32_32x32x16_bf16 v[112:127], v[68:71], v[72:75], v[112:127]
  ds_read_b64 v[100:101], v8 offset:1824
  ds_read_b64 v[102:103], v8 offset:1832
  s_waitcnt lgkmcnt(6)
  v_mfma_f32_32x32x16_bf16 v[16:31], v[80:83], v[88:91], v[16:31]
  v_mfma_f32_32x32x16_bf16 v[32:47], v[80:83], v[92:95], v[32:47]
  v_mfma_f32_32x32x16_bf16 v[112:127], v[84:87], v[88:91], v[112:127]
  s_waitcnt lgkmcnt(0)
  v_mfma_f32_32x32x16_bf16 v[16:31], v[96:99], v[104:107], v[16:31]
  v_mfma_f32_32x32x16_bf16 v[32:47], v[96:99], v[108:111], v[32:47]
  v_mfma_f32_32x32x16_bf16 v[112:127], v[100:103], v[104:107], v[112:127]
  v_and_b32 v3, 31, v1
  v_lshrrev_b32 v4, 5, v1
  v_mul_u32_u24 v6, 80, v3
  v_lshl_add_u32 v6, v4, 3, v6
  s_mul_i32 s32, s3, 16704
  v_add_u32 v10, s32, v6
  s_nop 7
  v_pk_add_f32 v[32:33], v[32:33], v[112:113]
  v_pk_add_f32 v[34:35], v[34:35], v[114:115]
  v_pk_add_f32 v[36:37], v[36:37], v[116:117]
  v_pk_add_f32 v[38:39], v[38:39], v[118:119]
  v_pk_add_f32 v[40:41], v[40:41], v[120:121]
  v_pk_add_f32 v[42:43], v[42:43], v[122:123]
  v_pk_add_f32 v[44:45], v[44:45], v[124:125]
  v_pk_add_f32 v[46:47], v[46:47], v[126:127]
  v_cvt_pk_bf16_f32 v128, v16, v17
  v_cvt_pk_bf16_f32 v129, v18, v19
  ds_write_b64 v10, v[128:129] offset:0
  v_cvt_pk_bf16_f32 v130, v20, v21
  v_cvt_pk_bf16_f32 v131, v22, v23
  ds_write_b64 v10, v[130:131] offset:16
  v_cvt_pk_bf16_f32 v132, v24, v25
  v_cvt_pk_bf16_f32 v133, v26, v27
  ds_write_b64 v10, v[132:133] offset:32
  v_cvt_pk_bf16_f32 v134, v28, v29
  v_cvt_pk_bf16_f32 v135, v30, v31
  ds_write_b64 v10, v[134:135] offset:48
  v_cvt_pk_bf16_f32 v128, v32, v33
  v_cvt_pk_bf16_f32 v129, v34, v35
  ds_write_b64 v10, v[128:129] offset:2560
  v_cvt_pk_bf16_f32 v130, v36, v37
  v_cvt_pk_bf16_f32 v131, v38, v39
  ds_write_b64 v10, v[130:131] offset:2576
  v_cvt_pk_bf16_f32 v132, v40, v41
  v_cvt_pk_bf16_f32 v133, v42, v43
  ds_write_b64 v10, v[132:133] offset:2592
  v_cvt_pk_bf16_f32 v134, v44, v45
  v_cvt_pk_bf16_f32 v135, v46, v47
  ds_write_b64 v10, v[134:135] offset:2608
  s_branch ka_kernel_join
ka_kernel_xload:
  s_sub_u32 s34, s3, 4
  v_lshlrev_b32 v230, 4, v1
  s_mul_i32 s42, s34, 9216
  s_add_u32 s42, s42, 113408
  s_mul_i32 s43, s2, 36864
  s_mul_i32 s48, s34, 288
  s_add_u32 s43, s43, s48
  v_add_u32 v3, 0, v1
  v_mul_u32_u24 v4, 3641, v3
  v_lshrrev_b32 v4, 16, v4
  v_mul_u32_u24 v5, 18, v4
  v_sub_u32 v5, v3, v5
  v_mul_u32_u24 v4, 1152, v4
  v_lshl_add_u32 v100, v5, 4, v4
  v_add_u32 v3, 64, v1
  v_mul_u32_u24 v4, 3641, v3
  v_lshrrev_b32 v4, 16, v4
  v_mul_u32_u24 v5, 18, v4
  v_sub_u32 v5, v3, v5
  v_mul_u32_u24 v4, 1152, v4
  v_lshl_add_u32 v101, v5, 4, v4
  v_add_u32 v3, 128, v1
  v_mul_u32_u24 v4, 3641, v3
  v_lshrrev_b32 v4, 16, v4
  v_mul_u32_u24 v5, 18, v4
  v_sub_u32 v5, v3, v5
  v_mul_u32_u24 v4, 1152, v4
  v_lshl_add_u32 v102, v5, 4, v4
  v_add_u32 v3, 192, v1
  v_mul_u32_u24 v4, 3641, v3
  v_lshrrev_b32 v4, 16, v4
  v_mul_u32_u24 v5, 18, v4
  v_sub_u32 v5, v3, v5
  v_mul_u32_u24 v4, 1152, v4
  v_lshl_add_u32 v103, v5, 4, v4
  v_add_u32 v3, 256, v1
  v_mul_u32_u24 v4, 3641, v3
  v_lshrrev_b32 v4, 16, v4
  v_mul_u32_u24 v5, 18, v4
  v_sub_u32 v5, v3, v5
  v_mul_u32_u24 v4, 1152, v4
  v_lshl_add_u32 v104, v5, 4, v4
  v_add_u32 v3, 320, v1
  v_mul_u32_u24 v4, 3641, v3
  v_lshrrev_b32 v4, 16, v4
  v_mul_u32_u24 v5, 18, v4
  v_sub_u32 v5, v3, v5
  v_mul_u32_u24 v4, 1152, v4
  v_lshl_add_u32 v105, v5, 4, v4
  v_add_u32 v3, 384, v1
  v_mul_u32_u24 v4, 3641, v3
  v_lshrrev_b32 v4, 16, v4
  v_mul_u32_u24 v5, 18, v4
  v_sub_u32 v5, v3, v5
  v_mul_u32_u24 v4, 1152, v4
  v_lshl_add_u32 v106, v5, 4, v4
  v_add_u32 v3, 448, v1
  v_mul_u32_u24 v4, 3641, v3
  v_lshrrev_b32 v4, 16, v4
  v_mul_u32_u24 v5, 18, v4
  v_sub_u32 v5, v3, v5
  v_mul_u32_u24 v4, 1152, v4
  v_lshl_add_u32 v107, v5, 4, v4
  v_add_u32 v3, 512, v1
  v_mul_u32_u24 v4, 3641, v3
  v_lshrrev_b32 v4, 16, v4
  v_mul_u32_u24 v5, 18, v4
  v_sub_u32 v5, v3, v5
  v_mul_u32_u24 v4, 1152, v4
  v_lshl_add_u32 v108, v5, 4, v4
  s_add_u32 m0, s42, 0
  s_nop 0
  buffer_load_dwordx4 v100, s[44:47], s43 offen lds
  s_add_u32 m0, s42, 1024
  s_nop 0
  buffer_load_dwordx4 v101, s[44:47], s43 offen lds
  s_add_u32 m0, s42, 2048
  s_nop 0
  buffer_load_dwordx4 v102, s[44:47], s43 offen lds
  s_add_u32 m0, s42, 3072
  s_nop 0
  buffer_load_dwordx4 v103, s[44:47], s43 offen lds
  s_add_u32 m0, s42, 4096
  s_nop 0
  buffer_load_dwordx4 v104, s[44:47], s43 offen lds
  s_add_u32 m0, s42, 5120
  s_nop 0
  buffer_load_dwordx4 v105, s[44:47], s43 offen lds
  s_add_u32 m0, s42, 6144
  s_nop 0
  buffer_load_dwordx4 v106, s[44:47], s43 offen lds
  s_add_u32 m0, s42, 7168
  s_nop 0
  buffer_load_dwordx4 v107, s[44:47], s43 offen lds
  s_add_u32 m0, s42, 8192
  s_nop 0
  buffer_load_dwordx4 v108, s[44:47], s43 offen lds
  v_lshrrev_b32 v3, 4, v1
  v_lshrrev_b32 v4, 1, v3
  v_and_b32 v5, 1, v3
  v_bfe_u32 v6, v1, 2, 2
  v_lshl_add_u32 v6, v5, 2, v6
  v_lshl_add_u32 v6, v4, 4, v6
  v_mul_u32_u24 v6, 288, v6
  v_and_b32 v7, 3, v1
  v_lshl_add_u32 v6, v7, 3, v6
  v_add_u32 v231, s42, v6
  v_and_b32 v4, 15, v1
  v_lshl_add_u32 v232, v3, 3, v4
  v_lshlrev_b32 v232, 4, v232
  v_add_u32 v232, 4096, v232
  v_cmp_gt_u32 vcc, 8, v4
  v_mov_b32 v5, 0x7fffffff
  s_mul_i32 s48, s34, 288
  s_add_u32 s48, s48, s2
  v_cndmask_b32 v232, v5, v232, vcc
  s_mul_i32 s48, s48, 4608
  s_waitcnt vmcnt(0)
  ds_read_b64_tr_b16 v[112:113], v231 offset:0
  ds_read_b64_tr_b16 v[114:115], v231 offset:2304
  ds_read_b64_tr_b16 v[116:117], v231 offset:32
  ds_read_b64_tr_b16 v[118:119], v231 offset:2336
  ds_read_b64_tr_b16 v[120:121], v231 offset:64
  ds_read_b64_tr_b16 v[122:123], v231 offset:2368
  ds_read_b64_tr_b16 v[124:125], v231 offset:96
  ds_read_b64_tr_b16 v[126:127], v231 offset:2400
  ds_read_b64_tr_b16 v[128:129], v231 offset:128
  ds_read_b64_tr_b16 v[130:131], v231 offset:2432
  s_waitcnt lgkmcnt(0)
  s_add_u32 s49, s48, 0
  buffer_store_dwordx4 v[112:115], v230, s[68:71], s49 offen sc1
  s_add_u32 s49, s48, 1024
  buffer_store_dwordx4 v[116:119], v230, s[68:71], s49 offen sc1
  s_add_u32 s49, s48, 2048
  buffer_store_dwordx4 v[120:123], v230, s[68:71], s49 offen sc1
  s_add_u32 s49, s48, 3072
  buffer_store_dwordx4 v[124:127], v230, s[68:71], s49 offen sc1
  s_add_u32 s49, s48, 0
  buffer_store_dwordx4 v[128:131], v232, s[68:71], s49 offen sc1
  ds_read_b64_tr_b16 v[132:133], v231 offset:144
  ds_read_b64_tr_b16 v[134:135], v231 offset:2448
  ds_read_b64_tr_b16 v[136:137], v231 offset:176
  ds_read_b64_tr_b16 v[138:139], v231 offset:2480
  ds_read_b64_tr_b16 v[140:141], v231 offset:208
  ds_read_b64_tr_b16 v[142:143], v231 offset:2512
  ds_read_b64_tr_b16 v[144:145], v231 offset:240
  ds_read_b64_tr_b16 v[146:147], v231 offset:2544
  ds_read_b64_tr_b16 v[148:149], v231 offset:272
  ds_read_b64_tr_b16 v[150:151], v231 offset:2576
  s_waitcnt lgkmcnt(0)
  s_add_u32 s49, s48, 663552
  buffer_store_dwordx4 v[132:135], v230, s[68:71], s49 offen sc1
  s_add_u32 s49, s48, 664576
  buffer_store_dwordx4 v[136:139], v230, s[68:71], s49 offen sc1
  s_add_u32 s49, s48, 665600
  buffer_store_dwordx4 v[140:143], v230, s[68:71], s49 offen sc1
  s_add_u32 s49, s48, 666624
  buffer_store_dwordx4 v[144:147], v230, s[68:71], s49 offen sc1
  s_add_u32 s49, s48, 663552
  buffer_store_dwordx4 v[148:151], v232, s[68:71], s49 offen sc1
ka_kernel_join:
  s_waitcnt lgkmcnt(0)
  s_barrier
  v_lshrrev_b32 v3, 7, v0
  v_and_b32 v4, 127, v0
  v_lshrrev_b32 v7, 2, v4
  v_mul_u32_u24 v7, 80, v7
  v_and_b32 v6, 3, v4
  v_lshl_add_u32 v7, v6, 4, v7
  v_mul_u32_u24 v5, 16704, v3
  v_add_u32 v5, v5, v7
  v_mul_u32_u24 v6, 7600, v3
  v_add_u32 v6, v6, v7
  v_add_u32 v6, 69040, v6
  v_mul_u32_u24 v7, 4112, v3
  v_lshl_add_u32 v7, v4, 4, v7
  v_add_u32 v7, 96960, v7
  ds_read_b128 v[16:19], v5 offset:0
  ds_read_b128 v[20:23], v6 offset:0
  ds_read_b128 v[24:27], v7 offset:0
  ds_read_b128 v[28:31], v5 offset:2560
  ds_read_b128 v[32:35], v6 offset:2560
  ds_read_b128 v[36:39], v7 offset:2048
  v_lshlrev_b32 v240, 16, v240
  v_mov_b32 v241, v240
  s_waitcnt lgkmcnt(3)
  v_lshlrev_b32 v48, 16, v20
  v_and_b32 v49, 0xffff0000, v20
  v_pk_mul_f32 v[48:49], v[48:49], v[240:241]
  v_cvt_pk_bf16_f32 v52, v48, v49
  v_lshlrev_b32 v50, 16, v16
  v_and_b32 v51, 0xffff0000, v16
  v_lshlrev_b32 v48, 16, v52
  v_and_b32 v49, 0xffff0000, v52
  v_pk_add_f32 v[48:49], v[48:49], v[50:51]
  v_cvt_pk_bf16_f32 v52, v48, v49
  v_lshlrev_b32 v50, 16, v24
  v_and_b32 v51, 0xffff0000, v24
  v_lshlrev_b32 v48, 16, v52
  v_and_b32 v49, 0xffff0000, v52
  v_pk_add_f32 v[48:49], v[48:49], v[50:51]
  v_cvt_pk_bf16_f32 v16, v48, v49
  v_lshlrev_b32 v56, 16, v21
  v_and_b32 v57, 0xffff0000, v21
  v_pk_mul_f32 v[56:57], v[56:57], v[240:241]
  v_cvt_pk_bf16_f32 v60, v56, v57
  v_lshlrev_b32 v58, 16, v17
  v_and_b32 v59, 0xffff0000, v17
  v_lshlrev_b32 v56, 16, v60
  v_and_b32 v57, 0xffff0000, v60
  v_pk_add_f32 v[56:57], v[56:57], v[58:59]
  v_cvt_pk_bf16_f32 v60, v56, v57
  v_lshlrev_b32 v58, 16, v25
  v_and_b32 v59, 0xffff0000, v25
  v_lshlrev_b32 v56, 16, v60
  v_and_b32 v57, 0xffff0000, v60
  v_pk_add_f32 v[56:57], v[56:57], v[58:59]
  v_cvt_pk_bf16_f32 v17, v56, v57
  v_lshlrev_b32 v48, 16, v22
  v_and_b32 v49, 0xffff0000, v22
  v_pk_mul_f32 v[48:49], v[48:49], v[240:241]
  v_cvt_pk_bf16_f32 v52, v48, v49
  v_lshlrev_b32 v50, 16, v18
  v_and_b32 v51, 0xffff0000, v18
  v_lshlrev_b32 v48, 16, v52
  v_and_b32 v49, 0xffff0000, v52
  v_pk_add_f32 v[48:49], v[48:49], v[50:51]
  v_cvt_pk_bf16_f32 v52, v48, v49
  v_lshlrev_b32 v50, 16, v26
  v_and_b32 v51, 0xffff0000, v26
  v_lshlrev_b32 v48, 16, v52
  v_and_b32 v49, 0xffff0000, v52
  v_pk_add_f32 v[48:49], v[48:49], v[50:51]
  v_cvt_pk_bf16_f32 v18, v48, v49
  v_lshlrev_b32 v56, 16, v23
  v_and_b32 v57, 0xffff0000, v23
  v_pk_mul_f32 v[56:57], v[56:57], v[240:241]
  v_cvt_pk_bf16_f32 v60, v56, v57
  v_lshlrev_b32 v58, 16, v19
  v_and_b32 v59, 0xffff0000, v19
  v_lshlrev_b32 v56, 16, v60
  v_and_b32 v57, 0xffff0000, v60
  v_pk_add_f32 v[56:57], v[56:57], v[58:59]
  v_cvt_pk_bf16_f32 v60, v56, v57
  v_lshlrev_b32 v58, 16, v27
  v_and_b32 v59, 0xffff0000, v27
  v_lshlrev_b32 v56, 16, v60
  v_and_b32 v57, 0xffff0000, v60
  v_pk_add_f32 v[56:57], v[56:57], v[58:59]
  v_cvt_pk_bf16_f32 v19, v56, v57
  ds_write_b128 v5, v[16:19] offset:0
  s_waitcnt lgkmcnt(0)
  v_lshlrev_b32 v64, 16, v32
  v_and_b32 v65, 0xffff0000, v32
  v_pk_mul_f32 v[64:65], v[64:65], v[240:241]
  v_cvt_pk_bf16_f32 v68, v64, v65
  v_lshlrev_b32 v66, 16, v28
  v_and_b32 v67, 0xffff0000, v28
  v_lshlrev_b32 v64, 16, v68
  v_and_b32 v65, 0xffff0000, v68
  v_pk_add_f32 v[64:65], v[64:65], v[66:67]
  v_cvt_pk_bf16_f32 v68, v64, v65
  v_lshlrev_b32 v66, 16, v36
  v_and_b32 v67, 0xffff0000, v36
  v_lshlrev_b32 v64, 16, v68
  v_and_b32 v65, 0xffff0000, v68
  v_pk_add_f32 v[64:65], v[64:65], v[66:67]
  v_cvt_pk_bf16_f32 v28, v64, v65
  v_lshlrev_b32 v72, 16, v33
  v_and_b32 v73, 0xffff0000, v33
  v_pk_mul_f32 v[72:73], v[72:73], v[240:241]
  v_cvt_pk_bf16_f32 v76, v72, v73
  v_lshlrev_b32 v74, 16, v29
  v_and_b32 v75, 0xffff0000, v29
  v_lshlrev_b32 v72, 16, v76
  v_and_b32 v73, 0xffff0000, v76
  v_pk_add_f32 v[72:73], v[72:73], v[74:75]
  v_cvt_pk_bf16_f32 v76, v72, v73
  v_lshlrev_b32 v74, 16, v37
  v_and_b32 v75, 0xffff0000, v37
  v_lshlrev_b32 v72, 16, v76
  v_and_b32 v73, 0xffff0000, v76
  v_pk_add_f32 v[72:73], v[72:73], v[74:75]
  v_cvt_pk_bf16_f32 v29, v72, v73
  v_lshlrev_b32 v64, 16, v34
  v_and_b32 v65, 0xffff0000, v34
  v_pk_mul_f32 v[64:65], v[64:65], v[240:241]
  v_cvt_pk_bf16_f32 v68, v64, v65
  v_lshlrev_b32 v66, 16, v30
  v_and_b32 v67, 0xffff0000, v30
  v_lshlrev_b32 v64, 16, v68
  v_and_b32 v65, 0xffff0000, v68
  v_pk_add_f32 v[64:65], v[64:65], v[66:67]
  v_cvt_pk_bf16_f32 v68, v64, v65
  v_lshlrev_b32 v66, 16, v38
  v_and_b32 v67, 0xffff0000, v38
  v_lshlrev_b32 v64, 16, v68
  v_and_b32 v65, 0xffff0000, v68
  v_pk_add_f32 v[64:65], v[64:65], v[66:67]
  v_cvt_pk_bf16_f32 v30, v64, v65
  v_lshlrev_b32 v72, 16, v35
  v_and_b32 v73, 0xffff0000, v35
  v_pk_mul_f32 v[72:73], v[72:73], v[240:241]
  v_cvt_pk_bf16_f32 v76, v72, v73
  v_lshlrev_b32 v74, 16, v31
  v_and_b32 v75, 0xffff0000, v31
  v_lshlrev_b32 v72, 16, v76
  v_and_b32 v73, 0xffff0000, v76
  v_pk_add_f32 v[72:73], v[72:73], v[74:75]
  v_cvt_pk_bf16_f32 v76, v72, v73
  v_lshlrev_b32 v74, 16, v39
  v_and_b32 v75, 0xffff0000, v39
  v_lshlrev_b32 v72, 16, v76
  v_and_b32 v73, 0xffff0000, v76
  v_pk_add_f32 v[72:73], v[72:73], v[74:75]
  v_cvt_pk_bf16_f32 v31, v72, v73
  ds_write_b128 v5, v[28:31] offset:2560
  v_bfe_u32 v3, v1, 2, 2
  v_mul_u32_u24 v3, 16704, v3
  v_and_b32 v4, 3, v1
  v_lshl_add_u32 v3, v4, 3, v3
  v_bfe_u32 v4, v1, 4, 1
  v_lshl_add_u32 v3, v4, 5, v3
  v_lshrrev_b32 v4, 5, v1
  v_mul_u32_u24 v4, 80, v4
  v_add_u32 v3, v3, v4
  s_mul_i32 s32, s3, 640
  v_add_u32 v3, s32, v3
  v_lshrrev_b32 v5, 5, v1
  v_mul_u32_u24 v5, 36864, v5
  v_and_b32 v6, 31, v1
  v_lshl_add_u32 v5, v6, 4, v5
  s_lshr_b32 s33, s2, 2
  s_lshl_b32 s33, s33, 10
  s_bfe_u32 s34, s2, 0x10001
  s_lshl_b32 s34, s34, 9
  s_add_u32 s33, s33, s34
  s_and_b32 s34, s2, 1
  s_lshl_b32 s34, s34, 3
  s_add_u32 s33, s33, s34
  s_mul_i32 s34, s3, 294912
  s_add_u32 s33, s33, s34
  s_waitcnt lgkmcnt(0)
  s_barrier
  ds_read_b64_tr_b16 v[20:21], v3 offset:0
  ds_read_b64_tr_b16 v[22:23], v3 offset:160
  ds_read_b64_tr_b16 v[24:25], v3 offset:320
  ds_read_b64_tr_b16 v[26:27], v3 offset:480
  s_waitcnt lgkmcnt(3)
  s_add_u32 s34, s33, 0
  buffer_store_dwordx2 v[20:21], v5, s[56:59], s34 offen
  s_waitcnt lgkmcnt(2)
  s_add_u32 s34, s33, 73728
  buffer_store_dwordx2 v[22:23], v5, s[56:59], s34 offen
  s_waitcnt lgkmcnt(1)
  s_add_u32 s34, s33, 147456
  buffer_store_dwordx2 v[24:25], v5, s[56:59], s34 offen
  s_waitcnt lgkmcnt(0)
  s_add_u32 s34, s33, 221184
  buffer_store_dwordx2 v[26:27], v5, s[56:59], s34 offen
  s_branch ka_kernel_fin
ka_kernel_aux:
  v_and_b32 v1, 63, v0
  v_lshrrev_b32 v2, 6, v0
  s_load_dwordx2 s[8:9], s[0:1], 96
  v_readfirstlane_b32 s3, v2
  s_sub_u32 s66, s2, 144
  s_cmp_lg_u32 s66, 0
  s_cbranch_scc1 ka_kernel_nopub
  s_cmp_lg_u32 s3, 0
  s_cbranch_scc1 ka_kernel_nopub
  s_memrealtime s[32:33]
  s_waitcnt lgkmcnt(0)
  s_or_b32 s32, s32, 1
  v_mov_b32 v60, s32
  v_mov_b32 v61, 0
  s_mov_b64 exec, 1
  global_store_dword v61, v60, s[8:9] sc1
  s_mov_b64 exec, -1
ka_kernel_nopub:
  s_cmp_ge_u32 s66, 8
  s_cbranch_scc1 ka_kernel_nopf
  s_getpc_b64 s[94:95]
ka_kernel_pfpc:
  s_sub_u32 s94, s94, ka_kernel_pfpc-ka_kernel
  s_subb_u32 s95, s95, 0
  v_lshlrev_b32 v254, 7, v0
  v_min_u32 v254, all_code_end-ka_kernel-4, v254
  global_load_dword v255, v254, s[94:95]
ka_kernel_nopf:
  s_cmp_ge_u32 s66, 108
  s_cbranch_scc1 ka_kernel_fin
  s_load_dwordx2 s[36:37], s[0:1], 64
  s_load_dwordx2 s[38:39], s[0:1], 72
  s_load_dwordx2 s[40:41], s[0:1], 104
  v_lshrrev_b32 v100, 4, v1
  v_and_b32 v101, 15, v1
  v_lshlrev_b32 v102, 1, v100
  v_mul_u32_u24 v100, 9216, v100
  v_xor_b32 v103, v101, v102
  v_lshl_add_u32 v104, v103, 4, v100
  v_xor_b32 v103, 8, v103
  v_lshl_add_u32 v105, v103, 4, v100
  v_lshrrev_b32 v106, 5, v1
  v_bfe_u32 v107, v1, 4, 1
  v_bfe_u32 v108, v1, 2, 2
  v_and_b32 v109, 3, v1
  v_lshrrev_b32 v110, 1, v109
  v_lshlrev_b32 v111, 1, v108
  v_lshl_add_u32 v111, v110, 3, v111
  v_lshl_add_u32 v106, v106, 3, v108
  v_lshlrev_b32 v106, 8, v106
  v_mul_u32_u24 v110, 49152, v110
  v_add_u32 v106, v106, v110
  v_and_b32 v109, 1, v109
  v_lshl_add_u32 v106, v109, 3, v106
  s_lshl_b32 s42, s3, 1
  v_add_u32 v107, s42, v107
  v_xor_b32 v107, v107, v111
  v_lshl_add_u32 v106, v107, 4, v106
  v_lshlrev_b32 v107, 4, v1
  v_lshlrev_b32 v108, 2, v1
  v_mov_b32 v109, 0x3f803f80
  s_waitcnt lgkmcnt(0)
  s_mov_b32 s44, s36
  s_and_b32 s45, s37, 0xffff
  s_mov_b32 s46, 5308416
  s_mov_b32 s47, 0x20000
  s_mov_b32 s48, s38
  s_and_b32 s49, s39, 0xffff
  s_mov_b32 s50, 5308416
  s_mov_b32 s51, 0x20000
  s_add_u32 s52, s40, 0
  s_addc_u32 s53, s41, 0
  s_and_b32 s53, s53, 0xffff
  s_mov_b32 s54, 10616832
  s_mov_b32 s55, 0x20000
  s_add_u32 s56, s40, 10616832
  s_addc_u32 s57, s41, 0
  s_and_b32 s57, s57, 0xffff
  s_mov_b32 s58, 110592
  s_mov_b32 s59, 0x20000
  s_mul_i32 s60, s66, 57
  s_lshr_b32 s60, s60, 11
  s_mul_i32 s61, s60, 36
  s_sub_u32 s61, s66, s61
  s_and_b32 s62, s3, 3
  s_mul_i32 s63, s60, 192
  s_mul_i32 s64, s62, 48
  s_add_u32 s63, s63, s64
  s_mul_i32 s63, s63, 9216
  s_lshl_b32 s64, s61, 8
  s_add_u32 s63, s63, s64
  s_mul_i32 s64, s62, 12288
  s_cmp_ge_u32 s3, 4
  s_cbranch_scc1 aiss_up0
  s_add_u32 s65, s63, 0
  s_add_u32 m0, s64, 0
  s_nop 0
  buffer_load_dwordx4 v104, s[44:47], s65 offen lds
  s_add_u32 s65, s63, 36864
  s_add_u32 m0, s64, 1024
  s_nop 0
  buffer_load_dwordx4 v104, s[44:47], s65 offen lds
  s_add_u32 s65, s63, 73728
  s_add_u32 m0, s64, 2048
  s_nop 0
  buffer_load_dwordx4 v104, s[44:47], s65 offen lds
  s_add_u32 s65, s63, 110592
  s_add_u32 m0, s64, 3072
  s_nop 0
  buffer_load_dwordx4 v104, s[44:47], s65 offen lds
  s_add_u32 s65, s63, 147456
  s_add_u32 m0, s64, 4096
  s_nop 0
  buffer_load_dwordx4 v104, s[44:47], s65 offen lds
  s_add_u32 s65, s63, 184320
  s_add_u32 m0, s64, 5120
  s_nop 0
  buffer_load_dwordx4 v104, s[44:47], s65 offen lds
  s_add_u32 s65, s63, 221184
  s_add_u32 m0, s64, 6144
  s_nop 0
  buffer_load_dwordx4 v104, s[44:47], s65 offen lds
  s_add_u32 s65, s63, 258048
  s_add_u32 m0, s64, 7168
  s_nop 0
  buffer_load_dwordx4 v104, s[44:47], s65 offen lds
  s_add_u32 s65, s63, 294912
  s_add_u32 m0, s64, 8192
  s_nop 0
  buffer_load_dwordx4 v104, s[44:47], s65 offen lds
  s_add_u32 s65, s63, 331776
  s_add_u32 m0, s64, 9216
  s_nop 0
  buffer_load_dwordx4 v104, s[44:47], s65 offen lds
  s_add_u32 s65, s63, 368640
  s_add_u32 m0, s64, 10240
  s_nop 0
  buffer_load_dwordx4 v104, s[44:47], s65 offen lds
  s_add_u32 s65, s63, 405504
  s_add_u32 m0, s64, 11264
  s_nop 0
  buffer_load_dwordx4 v104, s[44:47], s65 offen lds
  s_branch aiss_dn0
aiss_up0:
  s_add_u32 s65, s63, 0
  s_add_u32 m0, s64, 49152
  s_nop 0
  buffer_load_dwordx4 v105, s[48:51], s65 offen lds
  s_add_u32 s65, s63, 36864
  s_add_u32 m0, s64, 50176
  s_nop 0
  buffer_load_dwordx4 v105, s[48:51], s65 offen lds
  s_add_u32 s65, s63, 73728
  s_add_u32 m0, s64, 51200
  s_nop 0
  buffer_load_dwordx4 v105, s[48:51], s65 offen lds
  s_add_u32 s65, s63, 110592
  s_add_u32 m0, s64, 52224
  s_nop 0
  buffer_load_dwordx4 v105, s[48:51], s65 offen lds
  s_add_u32 s65, s63, 147456
  s_add_u32 m0, s64, 53248
  s_nop 0
  buffer_load_dwordx4 v105, s[48:51], s65 offen lds
  s_add_u32 s65, s63, 184320
  s_add_u32 m0, s64, 54272
  s_nop 0
  buffer_load_dwordx4 v105, s[48:51], s65 offen lds
  s_add_u32 s65, s63, 221184
  s_add_u32 m0, s64, 55296
  s_nop 0
  buffer_load_dwordx4 v105, s[48:51], s65 offen lds
  s_add_u32 s65, s63, 258048
  s_add_u32 m0, s64, 56320
  s_nop 0
  buffer_load_dwordx4 v105, s[48:51], s65 offen lds
  s_add_u32 s65, s63, 294912
  s_add_u32 m0, s64, 57344
  s_nop 0
  buffer_load_dwordx4 v105, s[48:51], s65 offen lds
  s_add_u32 s65, s63, 331776
  s_add_u32 m0, s64, 58368
  s_nop 0
  buffer_load_dwordx4 v105, s[48:51], s65 offen lds
  s_add_u32 s65, s63, 368640
  s_add_u32 m0, s64, 59392
  s_nop 0
  buffer_load_dwordx4 v105, s[48:51], s65 offen lds
  s_add_u32 s65, s63, 405504
  s_add_u32 m0, s64, 60416
  s_nop 0
  buffer_load_dwordx4 v105, s[48:51], s65 offen lds
aiss_dn0:
  s_waitcnt vmcnt(0)
  s_barrier
  s_mul_i32 s60, s66, 57
  s_lshr_b32 s60, s60, 11
  s_mul_i32 s61, s60, 36
  s_sub_u32 s61, s66, s61
  s_lshl_b32 s62, s61, 3
  s_add_u32 s62, s62, s3
  s_mul_i32 s63, s62, 36
  s_mul_i32 s64, s60, 12
  s_add_u32 s63, s63, s64
  s_lshl_b32 s63, s63, 10
  v_add_u32 v110, 0, v106
  v_mov_b32 v111, 0
  v_mov_b32 v112, 0
  ds_read_b64_tr_b16 v[120:121], v110 offset:0
  ds_read_b64_tr_b16 v[122:123], v110 offset:1024
  ds_read_b64_tr_b16 v[124:125], v110 offset:4096
  ds_read_b64_tr_b16 v[126:127], v110 offset:5120
  ds_read_b64_tr_b16 v[128:129], v110 offset:8192
  ds_read_b64_tr_b16 v[130:131], v110 offset:9216
  ds_read_b64_tr_b16 v[132:133], v110 offset:12288
  ds_read_b64_tr_b16 v[134:135], v110 offset:13312
  ds_read_b64_tr_b16 v[136:137], v110 offset:16384
  ds_read_b64_tr_b16 v[138:139], v110 offset:17408
  ds_read_b64_tr_b16 v[140:141], v110 offset:20480
  ds_read_b64_tr_b16 v[142:143], v110 offset:21504
  ds_read_b64_tr_b16 v[144:145], v110 offset:24576
  ds_read_b64_tr_b16 v[146:147], v110 offset:25600
  s_waitcnt lgkmcnt(12)
  v_dot2c_f32_bf16 v111, v120, v109
  v_dot2c_f32_bf16 v112, v121, v109
  v_dot2c_f32_bf16 v111, v122, v109
  v_dot2c_f32_bf16 v112, v123, v109
  s_add_u32 s64, s63, 0
  buffer_store_dwordx4 v[120:123], v107, s[52:55], s64 offen sc1
  ds_read_b64_tr_b16 v[148:149], v110 offset:28672
  ds_read_b64_tr_b16 v[150:151], v110 offset:29696
  s_waitcnt lgkmcnt(12)
  v_dot2c_f32_bf16 v111, v124, v109
  v_dot2c_f32_bf16 v112, v125, v109
  v_dot2c_f32_bf16 v111, v126, v109
  v_dot2c_f32_bf16 v112, v127, v109
  s_add_u32 s64, s63, 1024
  buffer_store_dwordx4 v[124:127], v107, s[52:55], s64 offen sc1
  ds_read_b64_tr_b16 v[152:153], v110 offset:32768
  ds_read_b64_tr_b16 v[154:155], v110 offset:33792
  s_waitcnt lgkmcnt(12)
  v_dot2c_f32_bf16 v111, v128, v109
  v_dot2c_f32_bf16 v112, v129, v109
  v_dot2c_f32_bf16 v111, v130, v109
  v_dot2c_f32_bf16 v112, v131, v109
  s_add_u32 s64, s63, 2048
  buffer_store_dwordx4 v[128:131], v107, s[52:55], s64 offen sc1
  ds_read_b64_tr_b16 v[156:157], v110 offset:36864
  ds_read_b64_tr_b16 v[158:159], v110 offset:37888
  s_waitcnt lgkmcnt(12)
  v_dot2c_f32_bf16 v111, v132, v109
  v_dot2c_f32_bf16 v112, v133, v109
  v_dot2c_f32_bf16 v111, v134, v109
  v_dot2c_f32_bf16 v112, v135, v109
  s_add_u32 s64, s63, 3072
  buffer_store_dwordx4 v[132:135], v107, s[52:55], s64 offen sc1
  ds_read_b64_tr_b16 v[160:161], v110 offset:40960
  ds_read_b64_tr_b16 v[162:163], v110 offset:41984
  s_waitcnt lgkmcnt(12)
  v_dot2c_f32_bf16 v111, v136, v109
  v_dot2c_f32_bf16 v112, v137, v109
  v_dot2c_f32_bf16 v111, v138, v109
  v_dot2c_f32_bf16 v112, v139, v109
  s_add_u32 s64, s63, 4096
  buffer_store_dwordx4 v[136:139], v107, s[52:55], s64 offen sc1
  ds_read_b64_tr_b16 v[164:165], v110 offset:45056
  ds_read_b64_tr_b16 v[166:167], v110 offset:46080
  s_waitcnt lgkmcnt(12)
  v_dot2c_f32_bf16 v111, v140, v109
  v_dot2c_f32_bf16 v112, v141, v109
  v_dot2c_f32_bf16 v111, v142, v109
  v_dot2c_f32_bf16 v112, v143, v109
  s_add_u32 s64, s63, 5120
  buffer_store_dwordx4 v[140:143], v107, s[52:55], s64 offen sc1
  s_waitcnt lgkmcnt(10)
  v_dot2c_f32_bf16 v111, v144, v109
  v_dot2c_f32_bf16 v112, v145, v109
  v_dot2c_f32_bf16 v111, v146, v109
  v_dot2c_f32_bf16 v112, v147, v109
  s_add_u32 s64, s63, 6144
  buffer_store_dwordx4 v[144:147], v107, s[52:55], s64 offen sc1
  s_waitcnt lgkmcnt(8)
  v_dot2c_f32_bf16 v111, v148, v109
  v_dot2c_f32_bf16 v112, v149, v109
  v_dot2c_f32_bf16 v111, v150, v109
  v_dot2c_f32_bf16 v112, v151, v109
  s_add_u32 s64, s63, 7168
  buffer_store_dwordx4 v[148:151], v107, s[52:55], s64 offen sc1
  s_waitcnt lgkmcnt(6)
  v_dot2c_f32_bf16 v111, v152, v109
  v_dot2c_f32_bf16 v112, v153, v109
  v_dot2c_f32_bf16 v111, v154, v109
  v_dot2c_f32_bf16 v112, v155, v109
  s_add_u32 s64, s63, 8192
  buffer_store_dwordx4 v[152:155], v107, s[52:55], s64 offen sc1
  s_waitcnt lgkmcnt(4)
  v_dot2c_f32_bf16 v111, v156, v109
  v_dot2c_f32_bf16 v112, v157, v109
  v_dot2c_f32_bf16 v111, v158, v109
  v_dot2c_f32_bf16 v112, v159, v109
  s_add_u32 s64, s63, 9216
  buffer_store_dwordx4 v[156:159], v107, s[52:55], s64 offen sc1
  s_waitcnt lgkmcnt(2)
  v_dot2c_f32_bf16 v111, v160, v109
  v_dot2c_f32_bf16 v112, v161, v109
  v_dot2c_f32_bf16 v111, v162, v109
  v_dot2c_f32_bf16 v112, v163, v109
  s_add_u32 s64, s63, 10240
  buffer_store_dwordx4 v[160:163], v107, s[52:55], s64 offen sc1
  s_waitcnt lgkmcnt(0)
  v_dot2c_f32_bf16 v111, v164, v109
  v_dot2c_f32_bf16 v112, v165, v109
  v_dot2c_f32_bf16 v111, v166, v109
  v_dot2c_f32_bf16 v112, v167, v109
  s_add_u32 s64, s63, 11264
  buffer_store_dwordx4 v[164:167], v107, s[52:55], s64 offen sc1
  s_nop 2
  v_add_f32 v111, v111, v112
  v_mov_b32 v112, v111
  s_nop 1
  v_permlane32_swap_b32 v111, v112
  s_nop 1
  v_add_f32 v111, v111, v112
  s_mul_i32 s64, s60, 288
  s_add_u32 s64, s64, s62
  s_lshl_b32 s64, s64, 7
  v_cmp_gt_u32 vcc, 32, v1
  v_mov_b32 v113, 0x7fffffff
  s_nop 0
  v_cndmask_b32 v113, v113, v108, vcc
  buffer_store_dword v111, v113, s[56:59], s64 offen sc1
ka_kernel_fin:
ka_kernel_end:
  s_endpgm
.p2align 4
.type ka_kernel_idx,@object
ka_kernel_idx:
.short 1280, 1280, 1280, 1280, 1278, 1278, 1278, 1278, 1278, 1278, 1278, 1276
.short 1278, 1278, 1278, 1276, 1276, 1276, 1276, 1276, 1276, 1276, 1276, 1276
.short 1276, 1276, 1276, 1276, 1274, 1274, 1274, 1274, 1274, 1274, 1274, 1272
.short 1274, 1274, 1274, 1272, 1272, 1272, 1272, 1272, 1272, 1272, 1272, 1272
.short 1272, 1272, 1272, 1272, 1270, 1270, 1270, 1270, 1270, 1270, 1270, 1268
.short 1270, 1270, 1270, 1268, 1268, 1268, 1268, 1268, 1268, 1268, 1268, 1268
.short 1268, 1268, 1268, 1268, 1266, 1266, 1266, 1266, 1266, 1266, 1266, 1264
.short 1266, 1266, 1266, 1264, 1264, 1264, 1264, 1264, 1264, 1264, 1264, 1264
.short 1264, 1264, 1264, 1264, 1262, 1262, 1262, 1262, 1262, 1262, 1262, 1260
.short 1262, 1262, 1262, 1260, 1260, 1260, 1260, 1260, 1260, 1260, 1260, 1260
.short 1260, 1260, 1260, 1260, 1258, 1258, 1258, 1258, 1258, 1258, 1258, 1256
.short 1258, 1258, 1258, 1256, 1256, 1256, 1256, 1256, 1256, 1256, 1256, 1256
.short 1256, 1256, 1256, 1256, 1254, 1254, 1254, 1254, 1254, 1254, 1254, 1252
.short 1254, 1254, 1254, 1252, 1252, 1252, 1252, 1252, 1252, 1252, 1252, 1252
.short 1252, 1252, 1252, 1252, 1250, 1250, 1250, 1250, 1250, 1250, 1250, 1248
.short 1250, 1250, 1250, 1248, 1248, 1248, 1248, 1248, 1248, 1248, 1248, 1248
.short 1248, 1248, 1248, 1248, 1246, 1246, 1246, 1246, 1246, 1246, 1246, 1244
.short 1246, 1246, 1246, 1244, 1244, 1244, 1244, 1244, 1244, 1244, 1244, 1244
.short 1244, 1244, 1244, 1244, 1242, 1242, 1242, 1242, 1242, 1242, 1242, 1240
.short 1242, 1242, 1242, 1240, 1240, 1240, 1240, 1240, 1240, 1240, 1240, 1240
.short 1240, 1240, 1240, 1240, 1238, 1238, 1238, 1238, 1238, 1238, 1238, 1236
.short 1238, 1238, 1238, 1236, 1236, 1236, 1236, 1236, 1236, 1236, 1236, 1236
.short 1236, 1236, 1236, 1236, 1234, 1234, 1234, 1234, 1234, 1234, 1234, 1232
.short 1234, 1234, 1234, 1232, 1232, 1232, 1232, 1232, 1232, 1232, 1232, 1232
.short 1232, 1232, 1232, 1232, 1230, 1230, 1230, 1230, 1230, 1230, 1230, 1228
.short 1230, 1230, 1230, 1228, 1228, 1228, 1228, 1228, 1228, 1228, 1228, 1228
.short 1228, 1228, 1228, 1228, 1226, 1226, 1226, 1226, 1226, 1226, 1226, 1224
.short 1226, 1226, 1226, 1224, 1224, 1224, 1224, 1224, 1224, 1224, 1224, 1224
.short 1224, 1224, 1224, 1224, 1222, 1222, 1222, 1222, 1222, 1222, 1222, 1220
.short 1222, 1222, 1222, 1220, 1220, 1220, 1220, 1220, 1220, 1220, 1220, 1220
.short 1220, 1220, 1220, 1220, 1218, 1218, 1218, 1218, 1218, 1218, 1218, 1216
.short 1218, 1218, 1218, 1216, 1216, 1216, 1216, 1216, 1216, 1216, 1216, 1216
.short 1216, 1216, 1216, 1216, 1214, 1214, 1214, 1214, 1214, 1214, 1214, 1212
.short 1214, 1214, 1214, 1212, 1212, 1212, 1212, 1212, 1212, 1212, 1212, 1212
.short 1212, 1212, 1212, 1212, 1210, 1210, 1210, 1210, 1210, 1210, 1210, 1208
.short 1210, 1210, 1210, 1208, 1208, 1208, 1208, 1208, 1208, 1208, 1208, 1208
.short 1208, 1208, 1208, 1208, 1206, 1206, 1206, 1206, 1206, 1206, 1206, 1204
.short 1206, 1206, 1206, 1204, 1204, 1204, 1204, 1204, 1204, 1204, 1204, 1204
.short 1204, 1204, 1204, 1204, 1202, 1202, 1202, 1202, 1202, 1202, 1202, 1200
.short 1202, 1202, 1202, 1200, 1200, 1200, 1200, 1200, 1200, 1200, 1200, 1200
.short 1200, 1200, 1200, 1200, 1198, 1198, 1198, 1198, 1198, 1198, 1198, 1196
.short 1198, 1198, 1198, 1196, 1196, 1196, 1196, 1196, 1196, 1196, 1196, 1196
.short 1196, 1196, 1196, 1196, 1194, 1194, 1194, 1194, 1194, 1194, 1194, 1192
.short 1194, 1194, 1194, 1192, 1192, 1192, 1192, 1192, 1192, 1192, 1192, 1192
.short 1192, 1192, 1192, 1192, 1190, 1190, 1190, 1190, 1190, 1190, 1190, 1188
.short 1190, 1190, 1190, 1188, 1188, 1188, 1188, 1188, 1188, 1188, 1188, 1188
.short 1188, 1188, 1188, 1188, 1186, 1186, 1186, 1186, 1186, 1186, 1186, 1184
.short 1186, 1186, 1186, 1184, 1184, 1184, 1184, 1184, 1184, 1184, 1184, 1184
.short 1184, 1184, 1184, 1184, 1182, 1182, 1182, 1182, 1182, 1182, 1182, 1180
.short 1182, 1182, 1182, 1180, 1180, 1180, 1180, 1180, 1180, 1180, 1180, 1180
.short 1180, 1180, 1180, 1180, 1178, 1178, 1178, 1178, 1178, 1178, 1178, 1176
.short 1178, 1178, 1178, 1176, 1176, 1176, 1176, 1176, 1176, 1176, 1176, 1176
.short 1176, 1176, 1176, 1176, 1174, 1174, 1174, 1174, 1174, 1174, 1174, 1172
.short 1174, 1174, 1174, 1172, 1172, 1172, 1172, 1172, 1172, 1172, 1172, 1172
.short 1172, 1172, 1172, 1172, 1170, 1170, 1170, 1170, 1170, 1170, 1170, 1168
.short 1170, 1170, 1170, 1168, 1168, 1168, 1168, 1168, 1168, 1168, 1168, 1168
.short 1168, 1168, 1168, 1168, 1166, 1166, 1166, 1166, 1166, 1166, 1166, 1164
.short 1166, 1166, 1166, 1164, 1164, 1164, 1164, 1164, 1164, 1164, 1164, 1164
.short 1164, 1164, 1164, 1164, 1162, 1162, 1162, 1162, 1162, 1162, 1162, 1160
.short 1162, 1162, 1162, 1160, 1160, 1160, 1160, 1160, 1160, 1160, 1160, 1160
.short 1160, 1160, 1160, 1160, 1158, 1158, 1158, 1158, 1158, 1158, 1158, 1156
.short 1158, 1158, 1158, 1156, 1156, 1156, 1156, 1156, 1156, 1156, 1156, 1156
.short 1156, 1156, 1156, 1156, 1154, 1154, 1154, 1154, 1154, 1154, 1154, 1152
.short 1154, 1154, 1154, 1152, 1152, 1152, 1152, 1152, 1152, 1152, 1152, 1152
.short 1152, 1152, 1152, 1152, 1150, 1150, 1150, 1150, 1150, 1150, 1150, 1148
.short 1150, 1150, 1150, 1148, 1148, 1148, 1148, 1148, 1148, 1148, 1148, 1148
.short 1148, 1148, 1148, 1148, 1146, 1146, 1146, 1146, 1146, 1146, 1146, 1144
.short 1146, 1146, 1146, 1144, 1144, 1144, 1144, 1144, 1144, 1144, 1144, 1144
.short 1144, 1144, 1144, 1144, 1142, 1142, 1142, 1142, 1142, 1142, 1142, 1140
.short 1142, 1142, 1142, 1140, 1140, 1140, 1140, 1140, 1140, 1140, 1140, 1140
.short 1140, 1140, 1140, 1140, 1138, 1138, 1138, 1138, 1138, 1138, 1138, 1136
.short 1138, 1138, 1138, 1136, 1136, 1136, 1136, 1136, 1136, 1136, 1136, 1136
.short 1136, 1136, 1136, 1136, 1134, 1134, 1134, 1134, 1134, 1134, 1134, 1132
.short 1134, 1134, 1134, 1132, 1132, 1132, 1132, 1132, 1132, 1132, 1132, 1132
.short 1132, 1132, 1132, 1132, 1130, 1130, 1130, 1130, 1130, 1130, 1130, 1128
.short 1130, 1130, 1130, 1128, 1128, 1128, 1128, 1128, 1128, 1128, 1128, 1128
.short 1128, 1128, 1128, 1128, 1126, 1126, 1126, 1126, 1126, 1126, 1126, 1124
.short 1126, 1126, 1126, 1124, 1124, 1124, 1124, 1124, 1124, 1124, 1124, 1124
.short 1124, 1124, 1124, 1124, 1122, 1122, 1122, 1122, 1122, 1122, 1122, 1120
.short 1122, 1122, 1122, 1120, 1120, 1120, 1120, 1120, 1120, 1120, 1120, 1120
.short 1120, 1120, 1120, 1120, 1118, 1118, 1118, 1118, 1118, 1118, 1118, 1116
.short 1118, 1118, 1118, 1116, 1116, 1116, 1116, 1116, 1116, 1116, 1116, 1116
.short 1116, 1116, 1116, 1116, 1114, 1114, 1114, 1114, 1114, 1114, 1114, 1112
.short 1114, 1114, 1114, 1112, 1112, 1112, 1112, 1112, 1112, 1112, 1112, 1112
.short 1112, 1112, 1112, 1112, 1110, 1110, 1110, 1110, 1110, 1110, 1110, 1108
.short 1110, 1110, 1110, 1108, 1108, 1108, 1108, 1108, 1108, 1108, 1108, 1108
.short 1108, 1108, 1108, 1108, 1106, 1106, 1106, 1106, 1106, 1106, 1106, 1104
.short 1106, 1106, 1106, 1104, 1104, 1104, 1104, 1104, 1104, 1104, 1104, 1104
.short 1104, 1104, 1104, 1104, 1102, 1102, 1102, 1102, 1102, 1102, 1102, 1100
.short 1102, 1102, 1102, 1100, 1100, 1100, 1100, 1100, 1100, 1100, 1100, 1100
.short 1100, 1100, 1100, 1100, 1098, 1098, 1098, 1098, 1098, 1098, 1098, 1096
.short 1098, 1098, 1098, 1096, 1096, 1096, 1096, 1096, 1096, 1096, 1096, 1096
.short 1096, 1096, 1096, 1096, 1094, 1094, 1094, 1094, 1094, 1094, 1094, 1092
.short 1094, 1094, 1094, 1092, 1092, 1092, 1092, 1092, 1092, 1092, 1092, 1092
.short 1092, 1092, 1092, 1092, 1090, 1090, 1090, 1090, 1090, 1090, 1090, 1088
.short 1090, 1090, 1090, 1088, 1088, 1088, 1088, 1088, 1088, 1088, 1088, 1088
.short 1088, 1088, 1088, 1088, 1086, 1086, 1086, 1086, 1086, 1086, 1086, 1084
.short 1086, 1086, 1086, 1084, 1084, 1084, 1084, 1084, 1084, 1084, 1084, 1084
.short 1084, 1084, 1084, 1084, 1082, 1082, 1082, 1082, 1082, 1082, 1082, 1080
.short 1082, 1082, 1082, 1080, 1080, 1080, 1080, 1080, 1080, 1080, 1080, 1080
.short 1080, 1080, 1080, 1080, 1078, 1078, 1078, 1078, 1078, 1078, 1078, 1076
.short 1078, 1078, 1078, 1076, 1076, 1076, 1076, 1076, 1076, 1076, 1076, 1076
.short 1076, 1076, 1076, 1076, 1074, 1074, 1074, 1074, 1074, 1074, 1074, 1072
.short 1074, 1074, 1074, 1072, 1072, 1072, 1072, 1072, 1072, 1072, 1072, 1072
.short 1072, 1072, 1072, 1072, 1070, 1070, 1070, 1070, 1070, 1070, 1070, 1068
.short 1070, 1070, 1070, 1068, 1068, 1068, 1068, 1068, 1068, 1068, 1068, 1068
.short 1068, 1068, 1068, 1068, 1066, 1066, 1066, 1066, 1066, 1066, 1066, 1064
.short 1066, 1066, 1066, 1064, 1064, 1064, 1064, 1064, 1064, 1064, 1064, 1064
.short 1064, 1064, 1064, 1064, 1062, 1062, 1062, 1062, 1062, 1062, 1062, 1060
.short 1062, 1062, 1062, 1060, 1060, 1060, 1060, 1060, 1060, 1060, 1060, 1060
.short 1060, 1060, 1060, 1060, 1058, 1058, 1058, 1058, 1058, 1058, 1058, 1056
.short 1058, 1058, 1058, 1056, 1056, 1056, 1056, 1056, 1056, 1056, 1056, 1056
.short 1056, 1056, 1056, 1056, 1054, 1054, 1054, 1054, 1054, 1054, 1054, 1052
.short 1054, 1054, 1054, 1052, 1052, 1052, 1052, 1052, 1052, 1052, 1052, 1052
.short 1052, 1052, 1052, 1052, 1050, 1050, 1050, 1050, 1050, 1050, 1050, 1048
.short 1050, 1050, 1050, 1048, 1048, 1048, 1048, 1048, 1048, 1048, 1048, 1048
.short 1048, 1048, 1048, 1048, 1046, 1046, 1046, 1046, 1046, 1046, 1046, 1044
.short 1046, 1046, 1046, 1044, 1044, 1044, 1044, 1044, 1044, 1044, 1044, 1044
.short 1044, 1044, 1044, 1044, 1042, 1042, 1042, 1042, 1042, 1042, 1042, 1040
.short 1042, 1042, 1042, 1040, 1040, 1040, 1040, 1040, 1040, 1040, 1040, 1040
.short 1040, 1040, 1040, 1040, 1038, 1038, 1038, 1038, 1038, 1038, 1038, 1036
.short 1038, 1038, 1038, 1036, 1036, 1036, 1036, 1036, 1036, 1036, 1036, 1036
.short 1036, 1036, 1036, 1036, 1034, 1034, 1034, 1034, 1034, 1034, 1034, 1032
.short 1034, 1034, 1034, 1032, 1032, 1032, 1032, 1032, 1032, 1032, 1032, 1032
.short 1032, 1032, 1032, 1032, 1030, 1030, 1030, 1030, 1030, 1030, 1030, 1028
.short 1030, 1030, 1030, 1028, 1028, 1028, 1028, 1028, 1028, 1028, 1028, 1028
.short 1028, 1028, 1028, 1028, 1026, 1026, 1026, 1026, 1026, 1026, 1026, 1024
.short 1026, 1026, 1026, 1024, 1024, 1024, 1024, 1024, 1024, 1024, 1022, 1022
.short 1024, 1024, 1022, 1022, 1022, 990, 990, 990, 990, 990, 1020, 1020
.short 990, 990, 1020, 1020, 1020, 988, 988, 988, 988, 988, 1018, 1018
.short 988, 988, 1018, 1018, 1018, 986, 986, 986, 986, 986, 1016, 1016
.short 986, 986, 1016, 1016, 1016, 984, 984, 984, 984, 984, 1014, 1014
.short 984, 984, 1014, 1014, 1014, 982, 982, 982, 982, 982, 1012, 1012
.short 982, 982, 1012, 1012, 1012, 980, 980, 980, 980, 980, 1010, 1010
.short 980, 980, 1010, 1010, 1010, 978, 978, 978, 978, 978, 1008, 1008
.short 978, 978, 1008, 1008, 1008, 976, 976, 976, 976, 976, 1006, 1006
.short 976, 976, 1006, 1006, 1006, 974, 974, 974, 974, 974, 1004, 1004
.short 974, 974, 1004, 1004, 1004, 972, 972, 972, 972, 972, 1002, 1002
.short 972, 972, 1002, 1002, 1002, 970, 970, 970, 970, 970, 1000, 1000
.short 970, 970, 1000, 1000, 1000, 968, 968, 968, 968, 968, 998, 998
.short 968, 968, 998, 998, 998, 966, 966, 966, 966, 966, 996, 996
.short 966, 966, 996, 996, 996, 964, 964, 964, 964, 964, 994, 994
.short 964, 964, 994, 994, 994, 962, 962, 962, 962, 962, 992, 992
.short 962, 962, 992, 992, 992, 960, 960, 960, 960, 960, 958, 958
.short 960, 960, 958, 958, 958, 926, 926, 926, 926, 926, 956, 956
.short 926, 926, 956, 956, 956, 924, 924, 924, 924, 924, 954, 954
.short 924, 924, 954, 954, 954, 922, 922, 922, 922, 922, 952, 952
.short 922, 922, 952, 952, 952, 920, 920, 920, 920, 920, 950, 950
.short 920, 920, 950, 950, 950, 918, 918, 918, 918, 918, 948, 948
.short 918, 918, 948, 948, 948, 916, 916, 916, 916, 916, 946, 946
.short 916, 916, 946, 946, 946, 914, 914, 914, 914, 914, 944, 944
.short 914, 914, 944, 944, 944, 912, 912, 912, 912, 912, 942, 942
.short 912, 912, 942, 942, 942, 910, 910, 910, 910, 910, 940, 940
.short 910, 910, 940, 940, 940, 908, 908, 908, 908, 908, 938, 938
.short 908, 908, 938, 938, 938, 906, 906, 906, 906, 906, 936, 936
.short 906, 906, 936, 936, 936, 904, 904, 904, 904, 904, 934, 934
.short 904, 904, 934, 934, 934, 902, 902, 902, 902, 902, 932, 932
.short 902, 902, 932, 932, 932, 900, 900, 900, 900, 900, 930, 930
.short 900, 900, 930, 930, 930, 898, 898, 898, 898, 898, 928, 928
.short 898, 898, 928, 928, 928, 896, 896, 896, 896, 896, 894, 894
.short 896, 896, 894, 894, 894, 862, 862, 862, 862, 862, 892, 892
.short 862, 862, 892, 892, 892, 860, 860, 860, 860, 860, 890, 890
.short 860, 860, 890, 890, 890, 858, 858, 858, 858, 858, 888, 888
.short 858, 858, 888, 888, 888, 856, 856, 856, 856, 856, 886, 886
.short 856, 856, 886, 886, 886, 854, 854, 854, 854, 854, 884, 884
.short 854, 854, 884, 884, 884, 852, 852, 852, 852, 852, 882, 882
.short 852, 852, 882, 882, 882, 850, 850, 850, 850, 850, 880, 880
.short 850, 850, 880, 880, 880, 848, 848, 848, 848, 848, 878, 878
.short 848, 848, 878, 878, 878, 846, 846, 846, 846, 846, 876, 876
.short 846, 846, 876, 876, 876, 844, 844, 844, 844, 844, 874, 874
.short 844, 844, 874, 874, 874, 842, 842, 842, 842, 842, 872, 872
.short 842, 842, 872, 872, 872, 840, 840, 840, 840, 840, 870, 870
.short 840, 840, 870, 870, 870, 838, 838, 838, 838, 838, 868, 868
.short 838, 838, 868, 868, 868, 836, 836, 836, 836, 836, 866, 866
.short 836, 836, 866, 866, 866, 834, 834, 834, 834, 834, 864, 864
.short 834, 834, 864, 864, 864, 832, 832, 832, 832, 832, 830, 830
.short 832, 832, 830, 830, 830, 798, 798, 798, 798, 798, 828, 828
.short 798, 798, 828, 828, 828, 796, 796, 796, 796, 796, 826, 826
.short 796, 796, 826, 826, 826, 794, 794, 794, 794, 794, 824, 824
.short 794, 794, 824, 824, 824, 792, 792, 792, 792, 792, 822, 822
.short 792, 792, 822, 822, 822, 790, 790, 790, 790, 790, 820, 820
.short 790, 790, 820, 820, 820, 788, 788, 788, 788, 788, 818, 818
.short 788, 788, 818, 818, 818, 786, 786, 786, 786, 786, 816, 816
.short 786, 786, 816, 816, 816, 784, 784, 784, 784, 784, 814, 814
.short 784, 784, 814, 814, 814, 782, 782, 782, 782, 782, 812, 812
.short 782, 782, 812, 812, 812, 780, 780, 780, 780, 780, 810, 810
.short 780, 780, 810, 810, 810, 778, 778, 778, 778, 778, 808, 808
.short 778, 778, 808, 808, 808, 776, 776, 776, 776, 776, 806, 806
.short 776, 776, 806, 806, 806, 774, 774, 774, 774, 774, 804, 804
.short 774, 774, 804, 804, 804, 772, 772, 772, 772, 772, 802, 802
.short 772, 772, 802, 802, 802, 770, 770, 770, 770, 770, 800, 800
.short 770, 770, 800, 800, 800, 768, 768, 768, 768, 766, 734, 734
.short 768, 766, 734, 734, 734, 702, 670, 670, 670, 764, 732, 732
.short 670, 764, 732, 732, 732, 700, 668, 668, 668, 762, 730, 730
.short 668, 762, 730, 730, 730, 698, 666, 666, 666, 760, 728, 728
.short 666, 760, 728, 728, 728, 696, 664, 664, 664, 758, 726, 726
.short 664, 758, 726, 726, 726, 694, 662, 662, 662, 756, 724, 724
.short 662, 756, 724, 724, 724, 692, 660, 660, 660, 754, 722, 722
.short 660, 754, 722, 722, 722, 690, 658, 658, 658, 752, 720, 720
.short 658, 752, 720, 720, 720, 688, 656, 656, 656, 750, 718, 718
.short 656, 750, 718, 718, 718, 686, 654, 654, 654, 748, 716, 716
.short 654, 748, 716, 716, 716, 684, 652, 652, 652, 746, 714, 714
.short 652, 746, 714, 714, 714, 682, 650, 650, 650, 744, 712, 712
.short 650, 744, 712, 712, 712, 680, 648, 648, 648, 742, 710, 710
.short 648, 742, 710, 710, 710, 678, 646, 646, 646, 740, 708, 708
.short 646, 740, 708, 708, 708, 676, 644, 644, 644, 738, 706, 706
.short 644, 738, 706, 706, 706, 674, 642, 642, 642, 736, 704, 704
.short 642, 736, 704, 704, 704, 672, 640, 640, 640, 638, 606, 606
.short 640, 638, 606, 606, 606, 574, 542, 542, 542, 636, 604, 604
.short 542, 636, 604, 604, 604, 572, 540, 540, 540, 634, 602, 602
.short 540, 634, 602, 602, 602, 570, 538, 538, 538, 632, 600, 600
.short 538, 632, 600, 600, 600, 568, 536, 536, 536, 630, 598, 598
.short 536, 630, 598, 598, 598, 566, 534, 534, 534, 628, 596, 596
.short 534, 628, 596, 596, 596, 564, 532, 532, 532, 626, 594, 594
.short 532, 626, 594, 594, 594, 562, 530, 530, 530, 624, 592, 592
.short 530, 624, 592, 592, 592, 560, 528, 528, 528, 622, 590, 590
.short 528, 622, 590, 590, 590, 558, 526, 526, 526, 620, 588, 588
.short 526, 620, 588, 588, 588, 556, 524, 524, 524, 618, 586, 586
.short 524, 618, 586, 586, 586, 554, 522, 522, 522, 616, 584, 584
.short 522, 616, 584, 584, 584, 552, 520, 520, 520, 614, 582, 582
.short 520, 614, 582, 582, 582, 550, 518, 518, 518, 612, 580, 580
.short 518, 612, 580, 580, 580, 548, 516, 516, 516, 610, 578, 578
.short 516, 610, 578, 578, 578, 546, 514, 514, 514, 608, 576, 576
.short 514, 608, 576, 576, 576, 544, 512, 512, 510, 478, 446, 414
.short 510, 478, 446, 414, 382, 350, 318, 286, 508, 476, 444, 412
.short 508, 476, 444, 412, 380, 348, 316, 284, 506, 474, 442, 410
.short 506, 474, 442, 410, 378, 346, 314, 282, 504, 472, 440, 408
.short 504, 472, 440, 408, 376, 344, 312, 280, 502, 470, 438, 406
.short 502, 470, 438, 406, 374, 342, 310, 278, 500, 468, 436, 404
.short 500, 468, 436, 404, 372, 340, 308, 276, 498, 466, 434, 402
.short 498, 466, 434, 402, 370, 338, 306, 274, 496, 464, 432, 400
.short 496, 464, 432, 400, 368, 336, 304, 272, 494, 462, 430, 398
.short 494, 462, 430, 398, 366, 334, 302, 270, 492, 460, 428, 396
.short 492, 460, 428, 396, 364, 332, 300, 268, 490, 458, 426, 394
.short 490, 458, 426, 394, 362, 330, 298, 266, 488, 456, 424, 392
.short 488, 456, 424, 392, 360, 328, 296, 264, 486, 454, 422, 390
.short 486, 454, 422, 390, 358, 326, 294, 262, 484, 452, 420, 388
.short 484, 452, 420, 388, 356, 324, 292, 260, 482, 450, 418, 386
.short 482, 450, 418, 386, 354, 322, 290, 258, 480, 448, 416, 384
.short 480, 448, 416, 384, 352, 320, 288, 256, 254, 222, 190, 158
.short 254, 222, 190, 158, 126, 94, 62, 30, 252, 220, 188, 156
.short 252, 220, 188, 156, 124, 92, 60, 28, 250, 218, 186, 154
.short 250, 218, 186, 154, 122, 90, 58, 26, 248, 216, 184, 152
.short 248, 216, 184, 152, 120, 88, 56, 24, 246, 214, 182, 150
.short 246, 214, 182, 150, 118, 86, 54, 22, 244, 212, 180, 148
.short 244, 212, 180, 148, 116, 84, 52, 20, 242, 210, 178, 146
.short 242, 210, 178, 146, 114, 82, 50, 18, 240, 208, 176, 144
.short 240, 208, 176, 144, 112, 80, 48, 16, 238, 206, 174, 142
.short 238, 206, 174, 142, 110, 78, 46, 14, 236, 204, 172, 140
.short 236, 204, 172, 140, 108, 76, 44, 12, 234, 202, 170, 138
.short 234, 202, 170, 138, 106, 74, 42, 10, 232, 200, 168, 136
.short 232, 200, 168, 136, 104, 72, 40, 8, 230, 198, 166, 134
.short 230, 198, 166, 134, 102, 70, 38, 6, 228, 196, 164, 132
.short 228, 196, 164, 132, 100, 68, 36, 4, 226, 194, 162, 130
.short 226, 194, 162, 130, 98, 66, 34, 2, 224, 192, 160, 128
.short 224, 192, 160, 128, 96, 64, 32, 0, 1536, 1536, 1536, 1536
.section .rodata,"a"
.p2align 6
.amdhsa_kernel ka_kernel
  .amdhsa_next_free_vgpr 256
  .amdhsa_next_free_sgpr 102
  .amdhsa_accum_offset 256
  .amdhsa_group_segment_fixed_size 0
  .amdhsa_kernarg_size 112
  .amdhsa_user_sgpr_count 2
  .amdhsa_user_sgpr_kernarg_segment_ptr 1
  .amdhsa_system_sgpr_workgroup_id_x 1
  .amdhsa_float_denorm_mode_32 3
  .amdhsa_float_denorm_mode_16_64 3
.end_amdhsa_kernel
.text
.globl gemm12_kernel
.p2align 8
.type gemm12_kernel,@function
gemm12_kernel:
  s_cmp_ge_u32 s2, 512
  s_cbranch_scc1 gemm12_kernel_end
  s_cmp_ge_u32 s2, 256
  s_cbranch_scc1 gemm12_kernel_r2
  s_load_dwordx2 s[10:11], s[0:1], 104
  v_and_b32 v11, 63, v0
  v_lshrrev_b32 v12, 6, v0
  s_and_b32 s4, s2, 3
  s_lshl_b32 s4, s4, 2
  s_bfe_u32 s5, s2, 0x20003
  s_add_u32 s4, s4, s5
  s_bfe_u32 s5, s2, 0x10002
  s_lshl_b32 s5, s5, 3
  s_lshr_b32 s6, s2, 5
  s_add_u32 s5, s5, s6
  v_readfirstlane_b32 s3, v12
  v_lshlrev_b32 v1, 4, v11
  s_mul_i32 s7, s3, 3072
  s_mov_b32 s28, s7
  s_mul_i32 s6, s4, 663552
  s_lshl_b32 s30, s5, 2
  s_add_u32 s30, s30, s3
  s_mul_i32 s8, s30, 36864
  s_waitcnt lgkmcnt(0)
  s_add_u32 s12, s10, 16777216
  s_addc_u32 s13, s11, 0
  s_and_b32 s13, s13, 0xffff
  s_mov_b32 s14, 2359296
  s_mov_b32 s15, 0x20000
  s_add_u32 s33, s8, 0
  buffer_load_dwordx4 v[112:115], v1, s[12:15], s33 offen offset:0
  buffer_load_dwordx4 v[116:119], v1, s[12:15], s33 offen offset:1024
  buffer_load_dwordx4 v[120:123], v1, s[12:15], s33 offen offset:2048
  buffer_load_dwordx4 v[124:127], v1, s[12:15], s33 offen offset:3072
  s_add_u32 s33, s8, 4096
  buffer_load_dwordx4 v[128:131], v1, s[12:15], s33 offen offset:0
  buffer_load_dwordx4 v[132:135], v1, s[12:15], s33 offen offset:1024
  buffer_load_dwordx4 v[136:139], v1, s[12:15], s33 offen offset:2048
  buffer_load_dwordx4 v[140:143], v1, s[12:15], s33 offen offset:3072
  s_add_u32 s33, s8, 8192
  buffer_load_dwordx4 v[144:147], v1, s[12:15], s33 offen offset:0
  buffer_load_dwordx4 v[148:151], v1, s[12:15], s33 offen offset:1024
  buffer_load_dwordx4 v[152:155], v1, s[12:15], s33 offen offset:2048
  buffer_load_dwordx4 v[156:159], v1, s[12:15], s33 offen offset:3072
  s_add_u32 s33, s8, 12288
  buffer_load_dwordx4 v[160:163], v1, s[12:15], s33 offen offset:0
  buffer_load_dwordx4 v[164:167], v1, s[12:15], s33 offen offset:1024
  buffer_load_dwordx4 v[168:171], v1, s[12:15], s33 offen offset:2048
  buffer_load_dwordx4 v[172:175], v1, s[12:15], s33 offen offset:3072
  s_add_u32 s16, s10, s6
  s_addc_u32 s17, s11, 0
  s_and_b32 s17, s17, 0xffff
  s_mov_b32 s18, 663552
  s_mov_b32 s19, 0x20000
  s_add_u32 s20, s10, 10616832
  s_addc_u32 s21, s11, 0
  s_and_b32 s21, s21, 0xffff
  s_mov_b32 s22, 110592
  s_mov_b32 s23, 0x20000
  s_add_u32 s24, s10, 33554432
  s_addc_u32 s25, s11, 0
  s_and_b32 s25, s25, 0xffff
  s_mov_b32 s26, 19922944
  s_mov_b32 s27, 0x20000
  s_add_u32 s40, s10, 24182784
  s_addc_u32 s41, s11, 0
  s_and_b32 s41, s41, 0xffff
  s_mov_b32 s42, 36864
  s_mov_b32 s43, 0x20000
  s_mul_i32 s29, s4, 18*128
  v_lshlrev_b32 v13, 2, v0
  v_add_u32 v14, 2048, v13
  v_cmp_gt_u32 vcc, 64, v0
  v_mov_b32 v15, 0x7fffffff
  v_add_u32 v2, 36864, v1
  v_cndmask_b32 v14, v15, v14, vcc
  v_mov_b32 v6, 0
  v_mov_b32 v7, 0
  v_mov_b32 v100, 0
  v_mov_b32 v101, 0
  v_mov_b32 v8, 0
  v_mov_b32 v9, 0
  v_mov_b32 v102, 0
  v_mov_b32 v103, 0
  v_mov_b32 v10, 0x3f803f80
  s_lshr_b32 s44, s30, 1
  s_mul_i32 s44, s44, 9*128
  s_mul_i32 s30, s30, 288
  s_mul_i32 s31, s4, 18
  s_add_u32 s30, s30, s31
  s_lshl_b32 s30, s30, 10
  s_mov_b32 s36, 0
  s_mov_b32 s45, 0
  s_lshl_b32 s31, s4, 2
  v_mov_b32 v98, s31
  v_mov_b32 v99, 0
  s_lshl_b32 s37, s2, 2
  s_add_u32 s37, s37, s3
  s_lshl_b32 s37, s37, 10
  s_add_u32 s37, s37, 18874368
  s_add_u32 s33, s8, 16384
  buffer_load_dwordx4 v[176:179], v1, s[12:15], s33 offen offset:0
  s_waitcnt vmcnt(16)
  v_dot2c_f32_bf16 v6, v112, v10
  v_dot2c_f32_bf16 v8, v112, v112
  v_dot2c_f32_bf16 v7, v113, v10
  v_dot2c_f32_bf16 v9, v113, v113
  v_dot2c_f32_bf16 v100, v114, v10
  v_dot2c_f32_bf16 v102, v114, v114
  v_dot2c_f32_bf16 v101, v115, v10
  v_dot2c_f32_bf16 v103, v115, v115
  buffer_load_dwordx4 v[180:183], v1, s[12:15], s33 offen offset:1024
  s_waitcnt vmcnt(16)
  v_dot2c_f32_bf16 v6, v116, v10
  v_dot2c_f32_bf16 v8, v116, v116
  v_dot2c_f32_bf16 v7, v117, v10
  v_dot2c_f32_bf16 v9, v117, v117
  v_dot2c_f32_bf16 v100, v118, v10
  v_dot2c_f32_bf16 v102, v118, v118
  v_dot2c_f32_bf16 v101, v119, v10
  v_dot2c_f32_bf16 v103, v119, v119
  buffer_load_dwordx4 v[184:187], v1, s[12:15], s33 offen offset:2048
  s_waitcnt vmcnt(16)
  v_dot2c_f32_bf16 v6, v120, v10
  v_dot2c_f32_bf16 v8, v120, v120
  v_dot2c_f32_bf16 v7, v121, v10
  v_dot2c_f32_bf16 v9, v121, v121
  v_dot2c_f32_bf16 v100, v122, v10
  v_dot2c_f32_bf16 v102, v122, v122
  v_dot2c_f32_bf16 v101, v123, v10
  v_dot2c_f32_bf16 v103, v123, v123
  buffer_load_dwordx4 v[188:191], v1, s[12:15], s33 offen offset:3072
  s_waitcnt vmcnt(16)
  v_dot2c_f32_bf16 v6, v124, v10
  v_dot2c_f32_bf16 v8, v124, v124
  v_dot2c_f32_bf16 v7, v125, v10
  v_dot2c_f32_bf16 v9, v125, v125
  v_dot2c_f32_bf16 v100, v126, v10
  v_dot2c_f32_bf16 v102, v126, v126
  v_dot2c_f32_bf16 v101, v127, v10
  v_dot2c_f32_bf16 v103, v127, v127
  s_add_u32 s33, s8, 20480
  buffer_load_dwordx4 v[192:195], v1, s[12:15], s33 offen offset:0
  s_waitcnt vmcnt(16)
  v_dot2c_f32_bf16 v6, v128, v10
  v_dot2c_f32_bf16 v8, v128, v128
  v_dot2c_f32_bf16 v7, v129, v10
  v_dot2c_f32_bf16 v9, v129, v129
  v_dot2c_f32_bf16 v100, v130, v10
  v_dot2c_f32_bf16 v102, v130, v130
  v_dot2c_f32_bf16 v101, v131, v10
  v_dot2c_f32_bf16 v103, v131, v131
  buffer_load_dwordx4 v[196:199], v1, s[12:15], s33 offen offset:1024
  s_waitcnt vmcnt(16)
  v_dot2c_f32_bf16 v6, v132, v10
  v_dot2c_f32_bf16 v8, v132, v132
  v_dot2c_f32_bf16 v7, v133, v10
  v_dot2c_f32_bf16 v9, v133, v133
  v_dot2c_f32_bf16 v100, v134, v10
  v_dot2c_f32_bf16 v102, v134, v134
  v_dot2c_f32_bf16 v101, v135, v10
  v_dot2c_f32_bf16 v103, v135, v135
  buffer_load_dwordx4 v[200:203], v1, s[12:15], s33 offen offset:2048
  s_waitcnt vmcnt(16)
  v_dot2c_f32_bf16 v6, v136, v10
  v_dot2c_f32_bf16 v8, v136, v136
  v_dot2c_f32_bf16 v7, v137, v10
  v_dot2c_f32_bf16 v9, v137, v137
  v_dot2c_f32_bf16 v100, v138, v10
  v_dot2c_f32_bf16 v102, v138, v138
  v_dot2c_f32_bf16 v101, v139, v10
  v_dot2c_f32_bf16 v103, v139, v139
  buffer_load_dwordx4 v[204:207], v1, s[12:15], s33 offen offset:3072
  s_waitcnt vmcnt(16)
  v_dot2c_f32_bf16 v6, v140, v10
  v_dot2c_f32_bf16 v8, v140, v140
  v_dot2c_f32_bf16 v7, v141, v10
  v_dot2c_f32_bf16 v9, v141, v141
  v_dot2c_f32_bf16 v100, v142, v10
  v_dot2c_f32_bf16 v102, v142, v142
  v_dot2c_f32_bf16 v101, v143, v10
  v_dot2c_f32_bf16 v103, v143, v143
  s_add_u32 s33, s8, 24576
  buffer_load_dwordx4 v[208:211], v1, s[12:15], s33 offen offset:0
  s_waitcnt vmcnt(16)
  v_dot2c_f32_bf16 v6, v144, v10
  v_dot2c_f32_bf16 v8, v144, v144
  v_dot2c_f32_bf16 v7, v145, v10
  v_dot2c_f32_bf16 v9, v145, v145
  v_dot2c_f32_bf16 v100, v146, v10
  v_dot2c_f32_bf16 v102, v146, v146
  v_dot2c_f32_bf16 v101, v147, v10
  v_dot2c_f32_bf16 v103, v147, v147
  buffer_load_dwordx4 v[212:215], v1, s[12:15], s33 offen offset:1024
  s_waitcnt vmcnt(16)
  v_dot2c_f32_bf16 v6, v148, v10
  v_dot2c_f32_bf16 v8, v148, v148
  v_dot2c_f32_bf16 v7, v149, v10
  v_dot2c_f32_bf16 v9, v149, v149
  v_dot2c_f32_bf16 v100, v150, v10
  v_dot2c_f32_bf16 v102, v150, v150
  v_dot2c_f32_bf16 v101, v151, v10
  v_dot2c_f32_bf16 v103, v151, v151
  buffer_load_dwordx4 v[216:219], v1, s[12:15], s33 offen offset:2048
  s_waitcnt vmcnt(16)
  v_dot2c_f32_bf16 v6, v152, v10
  v_dot2c_f32_bf16 v8, v152, v152
  v_dot2c_f32_bf16 v7, v153, v10
  v_dot2c_f32_bf16 v9, v153, v153
  v_dot2c_f32_bf16 v100, v154, v10
  v_dot2c_f32_bf16 v102, v154, v154
  v_dot2c_f32_bf16 v101, v155, v10
  v_dot2c_f32_bf16 v103, v155, v155
  buffer_load_dwordx4 v[220:223], v1, s[12:15], s33 offen offset:3072
  s_waitcnt vmcnt(16)
  v_dot2c_f32_bf16 v6, v156, v10
  v_dot2c_f32_bf16 v8, v156, v156
  v_dot2c_f32_bf16 v7, v157, v10
  v_dot2c_f32_bf16 v9, v157, v157
  v_dot2c_f32_bf16 v100, v158, v10
  v_dot2c_f32_bf16 v102, v158, v158
  v_dot2c_f32_bf16 v101, v159, v10
  v_dot2c_f32_bf16 v103, v159, v159
  s_add_u32 s33, s8, 28672
  buffer_load_dwordx4 v[224:227], v1, s[12:15], s33 offen offset:0
  s_waitcnt vmcnt(16)
  v_dot2c_f32_bf16 v6, v160, v10
  v_dot2c_f32_bf16 v8, v160, v160
  v_dot2c_f32_bf16 v7, v161, v10
  v_dot2c_f32_bf16 v9, v161, v161
  v_dot2c_f32_bf16 v100, v162, v10
  v_dot2c_f32_bf16 v102, v162, v162
  v_dot2c_f32_bf16 v101, v163, v10
  v_dot2c_f32_bf16 v103, v163, v163
  buffer_load_dwordx4 v[228:231], v1, s[12:15], s33 offen offset:1024
  s_waitcnt vmcnt(16)
  v_dot2c_f32_bf16 v6, v164, v10
  v_dot2c_f32_bf16 v8, v164, v164
  v_dot2c_f32_bf16 v7, v165, v10
  v_dot2c_f32_bf16 v9, v165, v165
  v_dot2c_f32_bf16 v100, v166, v10
  v_dot2c_f32_bf16 v102, v166, v166
  v_dot2c_f32_bf16 v101, v167, v10
  v_dot2c_f32_bf16 v103, v167, v167
  buffer_load_dwordx4 v[232:235], v1, s[12:15], s33 offen offset:2048
  s_waitcnt vmcnt(16)
  v_dot2c_f32_bf16 v6, v168, v10
  v_dot2c_f32_bf16 v8, v168, v168
  v_dot2c_f32_bf16 v7, v169, v10
  v_dot2c_f32_bf16 v9, v169, v169
  v_dot2c_f32_bf16 v100, v170, v10
  v_dot2c_f32_bf16 v102, v170, v170
  v_dot2c_f32_bf16 v101, v171, v10
  v_dot2c_f32_bf16 v103, v171, v171
  buffer_load_dwordx4 v[236:239], v1, s[12:15], s33 offen offset:3072
  s_waitcnt vmcnt(16)
  v_dot2c_f32_bf16 v6, v172, v10
  v_dot2c_f32_bf16 v8, v172, v172
  v_dot2c_f32_bf16 v7, v173, v10
  v_dot2c_f32_bf16 v9, v173, v173
  v_dot2c_f32_bf16 v100, v174, v10
  v_dot2c_f32_bf16 v102, v174, v174
  v_dot2c_f32_bf16 v101, v175, v10
  v_dot2c_f32_bf16 v103, v175, v175
  s_add_u32 s33, s8, 32768
  buffer_load_dwordx4 v[240:243], v1, s[12:15], s33 offen offset:0
  s_waitcnt vmcnt(16)
  v_dot2c_f32_bf16 v6, v176, v10
  v_dot2c_f32_bf16 v8, v176, v176
  v_dot2c_f32_bf16 v7, v177, v10
  v_dot2c_f32_bf16 v9, v177, v177
  v_dot2c_f32_bf16 v100, v178, v10
  v_dot2c_f32_bf16 v102, v178, v178
  v_dot2c_f32_bf16 v101, v179, v10
  v_dot2c_f32_bf16 v103, v179, v179
  buffer_load_dwordx4 v[244:247], v1, s[12:15], s33 offen offset:1024
  s_waitcnt vmcnt(16)
  v_dot2c_f32_bf16 v6, v180, v10
  v_dot2c_f32_bf16 v8, v180, v180
  v_dot2c_f32_bf16 v7, v181, v10
  v_dot2c_f32_bf16 v9, v181, v181
  v_dot2c_f32_bf16 v100, v182, v10
  v_dot2c_f32_bf16 v102, v182, v182
  v_dot2c_f32_bf16 v101, v183, v10
  v_dot2c_f32_bf16 v103, v183, v183
  buffer_load_dwordx4 v[248:251], v1, s[12:15], s33 offen offset:2048
  s_waitcnt vmcnt(16)
  v_dot2c_f32_bf16 v6, v184, v10
  v_dot2c_f32_bf16 v8, v184, v184
  v_dot2c_f32_bf16 v7, v185, v10
  v_dot2c_f32_bf16 v9, v185, v185
  v_dot2c_f32_bf16 v100, v186, v10
  v_dot2c_f32_bf16 v102, v186, v186
  v_dot2c_f32_bf16 v101, v187, v10
  v_dot2c_f32_bf16 v103, v187, v187
  buffer_load_dwordx4 v[252:255], v1, s[12:15], s33 offen offset:3072
  s_waitcnt vmcnt(16)
  v_dot2c_f32_bf16 v6, v188, v10
  v_dot2c_f32_bf16 v8, v188, v188
  v_dot2c_f32_bf16 v7, v189, v10
  v_dot2c_f32_bf16 v9, v189, v189
  v_dot2c_f32_bf16 v100, v190, v10
  v_dot2c_f32_bf16 v102, v190, v190
  v_dot2c_f32_bf16 v101, v191, v10
  v_dot2c_f32_bf16 v103, v191, v191
  s_add_u32 s34, s29, 0
  buffer_load_dword v16, v13, s[20:23], s34 offen offset:0
  s_add_u32 s34, s29, 36864
  buffer_load_dword v17, v13, s[20:23], s34 offen offset:0
  s_add_u32 s34, s29, 73728
  buffer_load_dword v18, v13, s[20:23], s34 offen offset:0
  s_add_u32 s34, s29, 0
  buffer_load_dword v20, v13, s[20:23], s34 offen offset:1024
  s_add_u32 s34, s29, 36864
  buffer_load_dword v21, v13, s[20:23], s34 offen offset:1024
  s_add_u32 s34, s29, 73728
  buffer_load_dword v22, v13, s[20:23], s34 offen offset:1024
  s_add_u32 s34, s29, 0
  buffer_load_dword v24, v14, s[20:23], s34 offen
  s_add_u32 s34, s29, 36864
  buffer_load_dword v25, v14, s[20:23], s34 offen
  s_add_u32 s34, s29, 73728
  buffer_load_dword v26, v14, s[20:23], s34 offen
  s_waitcnt vmcnt(24)
  v_dot2c_f32_bf16 v6, v192, v10
  v_dot2c_f32_bf16 v8, v192, v192
  v_dot2c_f32_bf16 v7, v193, v10
  v_dot2c_f32_bf16 v9, v193, v193
  v_dot2c_f32_bf16 v100, v194, v10
  v_dot2c_f32_bf16 v102, v194, v194
  v_dot2c_f32_bf16 v101, v195, v10
  v_dot2c_f32_bf16 v103, v195, v195
  s_waitcnt vmcnt(23)
  v_dot2c_f32_bf16 v6, v196, v10
  v_dot2c_f32_bf16 v8, v196, v196
  v_dot2c_f32_bf16 v7, v197, v10
  v_dot2c_f32_bf16 v9, v197, v197
  v_dot2c_f32_bf16 v100, v198, v10
  v_dot2c_f32_bf16 v102, v198, v198
  v_dot2c_f32_bf16 v101, v199, v10
  v_dot2c_f32_bf16 v103, v199, v199
  s_add_u32 m0, s7, 0
  s_nop 0
  buffer_load_dwordx4 v1, s[16:19], s28 offen offset:0 lds
  buffer_load_dwordx4 v1, s[16:19], s28 offen offset:1024 lds
  buffer_load_dwordx4 v1, s[16:19], s28 offen offset:2048 lds
  s_add_u32 s28, s28, 12288
  s_waitcnt vmcnt(25)
  v_dot2c_f32_bf16 v6, v200, v10
  v_dot2c_f32_bf16 v8, v200, v200
  v_dot2c_f32_bf16 v7, v201, v10
  v_dot2c_f32_bf16 v9, v201, v201
  v_dot2c_f32_bf16 v100, v202, v10
  v_dot2c_f32_bf16 v102, v202, v202
  v_dot2c_f32_bf16 v101, v203, v10
  v_dot2c_f32_bf16 v103, v203, v203
  s_waitcnt vmcnt(24)
  v_dot2c_f32_bf16 v6, v204, v10
  v_dot2c_f32_bf16 v8, v204, v204
  v_dot2c_f32_bf16 v7, v205, v10
  v_dot2c_f32_bf16 v9, v205, v205
  v_dot2c_f32_bf16 v100, v206, v10
  v_dot2c_f32_bf16 v102, v206, v206
  v_dot2c_f32_bf16 v101, v207, v10
  v_dot2c_f32_bf16 v103, v207, v207
  s_waitcnt vmcnt(23)
  v_dot2c_f32_bf16 v6, v208, v10
  v_dot2c_f32_bf16 v8, v208, v208
  v_dot2c_f32_bf16 v7, v209, v10
  v_dot2c_f32_bf16 v9, v209, v209
  v_dot2c_f32_bf16 v100, v210, v10
  v_dot2c_f32_bf16 v102, v210, v210
  v_dot2c_f32_bf16 v101, v211, v10
  v_dot2c_f32_bf16 v103, v211, v211
  s_add_u32 m0, s7, 12288
  s_nop 0
  buffer_load_dwordx4 v1, s[16:19], s28 offen offset:0 lds
  buffer_load_dwordx4 v1, s[16:19], s28 offen offset:1024 lds
  buffer_load_dwordx4 v1, s[16:19], s28 offen offset:2048 lds
  s_add_u32 s28, s28, 12288
  s_waitcnt vmcnt(25)
  v_dot2c_f32_bf16 v6, v212, v10
  v_dot2c_f32_bf16 v8, v212, v212
  v_dot2c_f32_bf16 v7, v213, v10
  v_dot2c_f32_bf16 v9, v213, v213
  v_dot2c_f32_bf16 v100, v214, v10
  v_dot2c_f32_bf16 v102, v214, v214
  v_dot2c_f32_bf16 v101, v215, v10
  v_dot2c_f32_bf16 v103, v215, v215
  s_waitcnt vmcnt(24)
  v_dot2c_f32_bf16 v6, v216, v10
  v_dot2c_f32_bf16 v8, v216, v216
  v_dot2c_f32_bf16 v7, v217, v10
  v_dot2c_f32_bf16 v9, v217, v217
  v_dot2c_f32_bf16 v100, v218, v10
  v_dot2c_f32_bf16 v102, v218, v218
  v_dot2c_f32_bf16 v101, v219, v10
  v_dot2c_f32_bf16 v103, v219, v219
  s_waitcnt vmcnt(23)
  v_dot2c_f32_bf16 v6, v220, v10
  v_dot2c_f32_bf16 v8, v220, v220
  v_dot2c_f32_bf16 v7, v221, v10
  v_dot2c_f32_bf16 v9, v221, v221
  v_dot2c_f32_bf16 v100, v222, v10
  v_dot2c_f32_bf16 v102, v222, v222
  v_dot2c_f32_bf16 v101, v223, v10
  v_dot2c_f32_bf16 v103, v223, v223
  s_add_u32 m0, s7, 24576
  s_nop 0
  buffer_load_dwordx4 v1, s[16:19], s28 offen offset:0 lds
  buffer_load_dwordx4 v1, s[16:19], s28 offen offset:1024 lds
  buffer_load_dwordx4 v1, s[16:19], s28 offen offset:2048 lds
  s_add_u32 s28, s28, 12288
  s_waitcnt vmcnt(25)
  v_dot2c_f32_bf16 v6, v224, v10
  v_dot2c_f32_bf16 v8, v224, v224
  v_dot2c_f32_bf16 v7, v225, v10
  v_dot2c_f32_bf16 v9, v225, v225
  v_dot2c_f32_bf16 v100, v226, v10
  v_dot2c_f32_bf16 v102, v226, v226
  v_dot2c_f32_bf16 v101, v227, v10
  v_dot2c_f32_bf16 v103, v227, v227
  s_waitcnt vmcnt(24)
  v_dot2c_f32_bf16 v6, v228, v10
  v_dot2c_f32_bf16 v8, v228, v228
  v_dot2c_f32_bf16 v7, v229, v10
  v_dot2c_f32_bf16 v9, v229, v229
  v_dot2c_f32_bf16 v100, v230, v10
  v_dot2c_f32_bf16 v102, v230, v230
  v_dot2c_f32_bf16 v101, v231, v10
  v_dot2c_f32_bf16 v103, v231, v231
  s_waitcnt vmcnt(23)
  v_dot2c_f32_bf16 v6, v232, v10
  v_dot2c_f32_bf16 v8, v232, v232
  v_dot2c_f32_bf16 v7, v233, v10
  v_dot2c_f32_bf16 v9, v233, v233
  v_dot2c_f32_bf16 v100, v234, v10
  v_dot2c_f32_bf16 v102, v234, v234
  v_dot2c_f32_bf16 v101, v235, v10
  v_dot2c_f32_bf16 v103, v235, v235
  s_add_u32 m0, s7, 36864
  s_nop 0
  buffer_load_dwordx4 v1, s[16:19], s28 offen offset:0 lds
  buffer_load_dwordx4 v1, s[16:19], s28 offen offset:1024 lds
  buffer_load_dwordx4 v1, s[16:19], s28 offen offset:2048 lds
  s_add_u32 s28, s28, 12288
  s_waitcnt vmcnt(25)
  v_dot2c_f32_bf16 v6, v236, v10
  v_dot2c_f32_bf16 v8, v236, v236
  v_dot2c_f32_bf16 v7, v237, v10
  v_dot2c_f32_bf16 v9, v237, v237
  v_dot2c_f32_bf16 v100, v238, v10
  v_dot2c_f32_bf16 v102, v238, v238
  v_dot2c_f32_bf16 v101, v239, v10
  v_dot2c_f32_bf16 v103, v239, v239
  s_waitcnt vmcnt(24)
  v_dot2c_f32_bf16 v6, v240, v10
  v_dot2c_f32_bf16 v8, v240, v240
  v_dot2c_f32_bf16 v7, v241, v10
  v_dot2c_f32_bf16 v9, v241, v241
  v_dot2c_f32_bf16 v100, v242, v10
  v_dot2c_f32_bf16 v102, v242, v242
  v_dot2c_f32_bf16 v101, v243, v10
  v_dot2c_f32_bf16 v103, v243, v243
  s_waitcnt vmcnt(23)
  v_dot2c_f32_bf16 v6, v244, v10
  v_dot2c_f32_bf16 v8, v244, v244
  v_dot2c_f32_bf16 v7, v245, v10
  v_dot2c_f32_bf16 v9, v245, v245
  v_dot2c_f32_bf16 v100, v246, v10
  v_dot2c_f32_bf16 v102, v246, v246
  v_dot2c_f32_bf16 v101, v247, v10
  v_dot2c_f32_bf16 v103, v247, v247
  s_waitcnt vmcnt(22)
  v_dot2c_f32_bf16 v6, v248, v10
  v_dot2c_f32_bf16 v8, v248, v248
  v_dot2c_f32_bf16 v7, v249, v10
  v_dot2c_f32_bf16 v9, v249, v249
  v_dot2c_f32_bf16 v100, v250, v10
  v_dot2c_f32_bf16 v102, v250, v250
  v_dot2c_f32_bf16 v101, v251, v10
  v_dot2c_f32_bf16 v103, v251, v251
  s_waitcnt vmcnt(21)
  v_dot2c_f32_bf16 v6, v252, v10
  v_dot2c_f32_bf16 v8, v252, v252
  v_dot2c_f32_bf16 v7, v253, v10
  v_dot2c_f32_bf16 v9, v253, v253
  v_dot2c_f32_bf16 v100, v254, v10
  v_dot2c_f32_bf16 v102, v254, v254
  v_dot2c_f32_bf16 v101, v255, v10
  v_dot2c_f32_bf16 v103, v255, v255
  s_nop 2
  v_add_f32 v6, v6, v7
  v_add_f32 v100, v100, v101
  v_add_f32 v8, v8, v9
  v_add_f32 v102, v102, v103
  v_add_f32 v6, v6, v100
  v_add_f32 v8, v8, v102
  v_mov_b32 v7, v6
  v_mov_b32 v9, v8
  s_nop 1
  v_permlane32_swap_b32 v6, v7
  v_permlane32_swap_b32 v8, v9
  s_nop 1
  v_add_f32 v6, v6, v7
  v_add_f32 v8, v8, v9
  s_mov_b32 s34, 0x3ae38e39
  v_mul_f32 v80, s34, v6
  v_mul_f32 v81, s34, v8
  v_fma_f32 v81, -v80, v80, v81
  v_max_f32 v81, 0, v81
  v_cvt_pk_bf16_f32 v81, v81, v81
  v_and_b32 v81, 0xffff0000, v81
  v_add_f32 v81, 0x3727c5ac, v81
  v_cvt_pk_bf16_f32 v81, v81, v81
  v_and_b32 v81, 0xffff0000, v81
  v_sqrt_f32 v81, v81
  s_nop 0
  v_cvt_pk_bf16_f32 v81, v81, v81
  v_and_b32 v81, 0xffff0000, v81
  v_rcp_f32 v81, v81
  v_cvt_pk_bf16_f32 v80, v80, v80
  v_mul_f32 v96, v81, v81
  v_xor_b32 v80, 0x80008000, v80
  v_and_b32 v82, 0xffff, v80
  v_cmp_gt_u32 vcc, 32, v11
  v_mov_b32 v74, 0
  v_mov_b32 v75, 0
  v_cndmask_b32 v72, 0, v80, vcc
  v_cndmask_b32 v73, 0, v82, vcc
  s_waitcnt vmcnt(12)
  v_add_f32 v16, v16, v17
  v_add_f32 v16, v16, v18
  v_cvt_pk_bf16_f32 v28, v16, v16
  v_and_b32 v28, 0xffff0000, v28
  v_sub_f32 v16, v16, v28
  v_cvt_pk_bf16_f32 v29, v16, v16
  v_and_b32 v29, 0xffff0000, v29
  v_sub_f32 v16, v16, v29
  v_cvt_pk_bf16_f32 v17, v16, v16
  v_lshrrev_b32 v28, 16, v28
  v_or_b32 v16, v28, v29
  v_and_b32 v17, 0xffff, v17
  v_lshlrev_b32 v13, 3, v0
  v_add_u32 v13, 73728, v13
  ds_write_b64 v13, v[16:17] offset:0
  v_add_f32 v20, v20, v21
  v_add_f32 v20, v20, v22
  v_cvt_pk_bf16_f32 v28, v20, v20
  v_and_b32 v28, 0xffff0000, v28
  v_sub_f32 v20, v20, v28
  v_cvt_pk_bf16_f32 v29, v20, v20
  v_and_b32 v29, 0xffff0000, v29
  v_sub_f32 v20, v20, v29
  v_cvt_pk_bf16_f32 v21, v20, v20
  v_lshrrev_b32 v28, 16, v28
  v_or_b32 v20, v28, v29
  v_and_b32 v21, 0xffff, v21
  ds_write_b64 v13, v[20:21] offset:2048
  v_add_f32 v24, v24, v25
  v_add_f32 v24, v24, v26
  v_cvt_pk_bf16_f32 v28, v24, v24
  v_and_b32 v28, 0xffff0000, v28
  v_sub_f32 v24, v24, v28
  v_cvt_pk_bf16_f32 v29, v24, v24
  v_and_b32 v29, 0xffff0000, v29
  v_sub_f32 v24, v24, v29
  v_cvt_pk_bf16_f32 v25, v24, v24
  v_lshrrev_b32 v28, 16, v28
  v_or_b32 v24, v28, v29
  v_and_b32 v25, 0xffff, v25
  v_cmp_gt_u32 vcc, 96, v0
  s_nop 0
  s_and_saveexec_b64 s[46:47], vcc
  ds_write_b64 v13, v[24:25] offset:4096
  s_mov_b64 exec, s[46:47]
  v_mov_b32 v66, 0
  v_mov_b32 v67, 0
  v_mov_b32 v70, 0
  v_mov_b32 v71, 0
  v_lshlrev_b32 v15, 3, v11
  v_add_u32 v15, 73728, v15
  s_waitcnt lgkmcnt(0)
  s_waitcnt vmcnt(9)
  s_barrier
  s_add_u32 m0, s7, 49152
  s_nop 0
  buffer_load_dwordx4 v1, s[16:19], s28 offen lds
  ds_read_b64 v[64:65], v15
  ds_read_b128 v[48:51], v1 offset:0
  ds_read_b128 v[52:55], v1 offset:1024
  ds_read_b128 v[56:59], v1 offset:2048
  s_waitcnt lgkmcnt(3)
  s_mov_b32 s32, 0
gemm12_kernel_loop1:
  v_mfma_f32_32x32x16_bf16 v[16:31], v[64:67], v[72:75], 0
  ds_read_b128 v[60:63], v1 offset:3072
  s_waitcnt lgkmcnt(3)
  v_mfma_f32_32x32x16_bf16 v[16:31], v[48:51], v[112:115], v[16:31]
  ds_read_b128 v[48:51], v1 offset:4096
  s_waitcnt lgkmcnt(3)
  v_mfma_f32_32x32x16_bf16 v[16:31], v[52:55], v[116:119], v[16:31]
  buffer_load_dwordx4 v1, s[16:19], s28 offen offset:1024 lds
  ds_read_b128 v[52:55], v1 offset:5120
  s_waitcnt lgkmcnt(3)
  v_mfma_f32_32x32x16_bf16 v[16:31], v[56:59], v[120:123], v[16:31]
  ds_read_b128 v[56:59], v1 offset:6144
  s_waitcnt lgkmcnt(3)
  v_mfma_f32_32x32x16_bf16 v[16:31], v[60:63], v[124:127], v[16:31]
  v_max_f32 v80, 0, v32
  v_mul_f32 v88, v36, v96
  v_mul_f32 v80, v80, v88
  v_max_f32 v81, 0, v33
  ds_read_b128 v[60:63], v1 offset:7168
  s_waitcnt lgkmcnt(3)
  v_mfma_f32_32x32x16_bf16 v[16:31], v[48:51], v[128:131], v[16:31]
  v_mul_f32 v89, v37, v96
  v_mul_f32 v81, v81, v89
  v_max_f32 v82, 0, v34
  v_mul_f32 v90, v38, v96
  ds_read_b128 v[48:51], v1 offset:8192
  s_waitcnt lgkmcnt(3)
  v_mfma_f32_32x32x16_bf16 v[16:31], v[52:55], v[132:135], v[16:31]
  v_mul_f32 v82, v82, v90
  v_max_f32 v83, 0, v35
  v_mul_f32 v91, v39, v96
  v_mul_f32 v83, v83, v91
  buffer_load_dwordx4 v1, s[16:19], s28 offen offset:2048 lds
  s_add_u32 s28, s28, 12288
  ds_read_b128 v[52:55], v1 offset:9216
  s_waitcnt lgkmcnt(3)
  v_mfma_f32_32x32x16_bf16 v[16:31], v[56:59], v[136:139], v[16:31]
  v_max_f32 v84, 0, v40
  v_mul_f32 v92, v44, v96
  v_mul_f32 v84, v84, v92
  v_max_f32 v85, 0, v41
  ds_read_b128 v[56:59], v1 offset:10240
  s_waitcnt lgkmcnt(3)
  v_mfma_f32_32x32x16_bf16 v[16:31], v[60:63], v[140:143], v[16:31]
  v_mul_f32 v93, v45, v96
  v_mul_f32 v85, v85, v93
  v_max_f32 v86, 0, v42
  v_mul_f32 v94, v46, v96
  ds_read_b128 v[60:63], v1 offset:11264
  s_waitcnt lgkmcnt(3)
  v_mfma_f32_32x32x16_bf16 v[16:31], v[48:51], v[144:147], v[16:31]
  v_mul_f32 v86, v86, v94
  v_max_f32 v87, 0, v43
  v_mul_f32 v95, v47, v96
  v_mul_f32 v87, v87, v95
  s_waitcnt vmcnt(9)
  s_barrier
  s_add_u32 m0, s7, 61440
  ds_read_b128 v[48:51], v1 offset:12288
  s_waitcnt lgkmcnt(3)
  v_mfma_f32_32x32x16_bf16 v[16:31], v[52:55], v[148:151], v[16:31]
  v_cvt_pk_bf16_f32 v76, v80, v81
  v_cvt_pk_bf16_f32 v77, v82, v83
  v_cvt_pk_bf16_f32 v78, v84, v85
  v_cvt_pk_bf16_f32 v79, v86, v87
  buffer_load_dwordx4 v1, s[16:19], s28 offen offset:0 lds
  ds_read_b128 v[52:55], v1 offset:13312
  s_waitcnt lgkmcnt(3)
  v_mfma_f32_32x32x16_bf16 v[16:31], v[56:59], v[152:155], v[16:31]
  ds_read_b128 v[56:59], v1 offset:14336
  s_waitcnt lgkmcnt(3)
  v_mfma_f32_32x32x16_bf16 v[16:31], v[60:63], v[156:159], v[16:31]
  buffer_store_dwordx4 v[76:79], v1, s[24:27], s37 offen sc1
  s_add_u32 s30, s30, s36
  s_mov_b32 s36, 1024
  s_mov_b32 s37, s30
  ds_read_b128 v[60:63], v1 offset:15360
  s_waitcnt lgkmcnt(3)
  v_mfma_f32_32x32x16_bf16 v[16:31], v[48:51], v[160:163], v[16:31]
  ds_read_b128 v[48:51], v1 offset:16384
  s_waitcnt lgkmcnt(3)
  v_mfma_f32_32x32x16_bf16 v[16:31], v[52:55], v[164:167], v[16:31]
  buffer_load_dwordx4 v1, s[16:19], s28 offen offset:1024 lds
  ds_read_b128 v[52:55], v1 offset:17408
  s_waitcnt lgkmcnt(3)
  v_mfma_f32_32x32x16_bf16 v[16:31], v[56:59], v[168:171], v[16:31]
  ds_read_b128 v[56:59], v1 offset:18432
  s_waitcnt lgkmcnt(3)
  v_mfma_f32_32x32x16_bf16 v[16:31], v[60:63], v[172:175], v[16:31]
  ds_read_b128 v[60:63], v1 offset:19456
  s_waitcnt lgkmcnt(3)
  v_mfma_f32_32x32x16_bf16 v[16:31], v[48:51], v[176:179], v[16:31]
  ds_read_b128 v[48:51], v1 offset:20480
  s_waitcnt lgkmcnt(3)
  v_mfma_f32_32x32x16_bf16 v[16:31], v[52:55], v[180:183], v[16:31]
  buffer_load_dwordx4 v1, s[16:19], s28 offen offset:2048 lds
  s_add_u32 s28, s28, 12288
  ds_read_b128 v[52:55], v1 offset:21504
  s_waitcnt lgkmcnt(3)
  v_mfma_f32_32x32x16_bf16 v[16:31], v[56:59], v[184:187], v[16:31]
  ds_read_b128 v[56:59], v1 offset:22528
  s_waitcnt lgkmcnt(3)
  v_mfma_f32_32x32x16_bf16 v[16:31], v[60:63], v[188:191], v[16:31]
  ds_read_b128 v[60:63], v1 offset:23552
  s_waitcnt lgkmcnt(3)
  v_mfma_f32_32x32x16_bf16 v[16:31], v[48:51], v[192:195], v[16:31]
  s_waitcnt vmcnt(10)
  s_barrier
  s_add_u32 m0, s7, 0
  ds_read_b128 v[48:51], v1 offset:24576
  s_waitcnt lgkmcnt(3)
  v_mfma_f32_32x32x16_bf16 v[16:31], v[52:55], v[196:199], v[16:31]
  buffer_load_dwordx4 v1, s[16:19], s28 offen offset:0 lds
  ds_read_b128 v[52:55], v1 offset:25600
  s_waitcnt lgkmcnt(3)
  v_mfma_f32_32x32x16_bf16 v[16:31], v[56:59], v[200:203], v[16:31]
  ds_read_b128 v[56:59], v1 offset:26624
  s_waitcnt lgkmcnt(3)
  v_mfma_f32_32x32x16_bf16 v[16:31], v[60:63], v[204:207], v[16:31]
  ds_read_b128 v[60:63], v1 offset:27648
  s_waitcnt lgkmcnt(3)
  v_mfma_f32_32x32x16_bf16 v[16:31], v[48:51], v[208:211], v[16:31]
  ds_read_b128 v[48:51], v1 offset:28672
  s_waitcnt lgkmcnt(3)
  v_mfma_f32_32x32x16_bf16 v[16:31], v[52:55], v[212:215], v[16:31]
  buffer_load_dwordx4 v1, s[16:19], s28 offen offset:1024 lds
  ds_read_b128 v[52:55], v1 offset:29696
  s_waitcnt lgkmcnt(3)
  v_mfma_f32_32x32x16_bf16 v[16:31], v[56:59], v[216:219], v[16:31]
  ds_read_b128 v[56:59], v1 offset:30720
  s_waitcnt lgkmcnt(3)
  v_mfma_f32_32x32x16_bf16 v[16:31], v[60:63], v[220:223], v[16:31]
  ds_read_b128 v[60:63], v1 offset:31744
  s_waitcnt lgkmcnt(3)
  v_mfma_f32_32x32x16_bf16 v[16:31], v[48:51], v[224:227], v[16:31]
  ds_read_b128 v[48:51], v1 offset:32768
  s_waitcnt lgkmcnt(3)
  v_mfma_f32_32x32x16_bf16 v[16:31], v[52:55], v[228:231], v[16:31]
  buffer_load_dwordx4 v1, s[16:19], s28 offen offset:2048 lds
  s_add_u32 s28, s28, 12288
  ds_read_b64 v[68:69], v15 offset:256
  ds_read_b128 v[52:55], v1 offset:33792
  s_waitcnt lgkmcnt(3)
  v_mfma_f32_32x32x16_bf16 v[16:31], v[56:59], v[232:235], v[16:31]
  ds_read_b128 v[56:59], v1 offset:34816
  s_waitcnt lgkmcnt(3)
  v_mfma_f32_32x32x16_bf16 v[16:31], v[60:63], v[236:239], v[16:31]
  ds_read_b128 v[60:63], v1 offset:35840
  s_waitcnt lgkmcnt(3)
  v_mfma_f32_32x32x16_bf16 v[16:31], v[48:51], v[240:243], v[16:31]
  s_waitcnt vmcnt(10)
  s_barrier
  s_add_u32 m0, s7, 12288
  ds_read_b128 v[48:51], v2 offset:0
  s_waitcnt lgkmcnt(3)
  v_mfma_f32_32x32x16_bf16 v[16:31], v[52:55], v[244:247], v[16:31]
  buffer_load_dwordx4 v1, s[16:19], s28 offen offset:0 lds
  ds_read_b128 v[52:55], v2 offset:1024
  s_waitcnt lgkmcnt(3)
  v_mfma_f32_32x32x16_bf16 v[16:31], v[56:59], v[248:251], v[16:31]
  ds_read_b128 v[56:59], v2 offset:2048
  s_waitcnt lgkmcnt(3)
  v_mfma_f32_32x32x16_bf16 v[16:31], v[60:63], v[252:255], v[16:31]
  v_mfma_f32_32x32x16_bf16 v[32:47], v[68:71], v[72:75], 0
  ds_read_b128 v[60:63], v2 offset:3072
  s_waitcnt lgkmcnt(3)
  v_mfma_f32_32x32x16_bf16 v[32:47], v[48:51], v[112:115], v[32:47]
  ds_read_b128 v[48:51], v2 offset:4096
  s_waitcnt lgkmcnt(3)
  v_mfma_f32_32x32x16_bf16 v[32:47], v[52:55], v[116:119], v[32:47]
  buffer_load_dwordx4 v1, s[16:19], s28 offen offset:1024 lds
  ds_read_b128 v[52:55], v2 offset:5120
  s_waitcnt lgkmcnt(3)
  v_mfma_f32_32x32x16_bf16 v[32:47], v[56:59], v[120:123], v[32:47]
  ds_read_b128 v[56:59], v2 offset:6144
  s_waitcnt lgkmcnt(3)
  v_mfma_f32_32x32x16_bf16 v[32:47], v[60:63], v[124:127], v[32:47]
  v_max_f32 v80, 0, v16
  v_mul_f32 v88, v20, v96
  v_mul_f32 v80, v80, v88
  v_max_f32 v81, 0, v17
  ds_read_b128 v[60:63], v2 offset:7168
  s_waitcnt lgkmcnt(3)
  v_mfma_f32_32x32x16_bf16 v[32:47], v[48:51], v[128:131], v[32:47]
  v_mul_f32 v89, v21, v96
  v_mul_f32 v81, v81, v89
  v_max_f32 v82, 0, v18
  v_mul_f32 v90, v22, v96
  ds_read_b128 v[48:51], v2 offset:8192
  s_waitcnt lgkmcnt(3)
  v_mfma_f32_32x32x16_bf16 v[32:47], v[52:55], v[132:135], v[32:47]
  v_mul_f32 v82, v82, v90
  v_max_f32 v83, 0, v19
  v_mul_f32 v91, v23, v96
  v_mul_f32 v83, v83, v91
  buffer_load_dwordx4 v1, s[16:19], s28 offen offset:2048 lds
  s_add_u32 s28, s28, 12288
  ds_read_b128 v[52:55], v2 offset:9216
  s_waitcnt lgkmcnt(3)
  v_mfma_f32_32x32x16_bf16 v[32:47], v[56:59], v[136:139], v[32:47]
  v_max_f32 v84, 0, v24
  v_mul_f32 v92, v28, v96
  v_mul_f32 v84, v84, v92
  v_max_f32 v85, 0, v25
  ds_read_b128 v[56:59], v2 offset:10240
  s_waitcnt lgkmcnt(3)
  v_mfma_f32_32x32x16_bf16 v[32:47], v[60:63], v[140:143], v[32:47]
  v_mul_f32 v93, v29, v96
  v_mul_f32 v85, v85, v93
  v_max_f32 v86, 0, v26
  v_mul_f32 v94, v30, v96
  ds_read_b128 v[60:63], v2 offset:11264
  s_waitcnt lgkmcnt(3)
  v_mfma_f32_32x32x16_bf16 v[32:47], v[48:51], v[144:147], v[32:47]
  v_mul_f32 v86, v86, v94
  v_max_f32 v87, 0, v27
  v_mul_f32 v95, v31, v96
  v_mul_f32 v87, v87, v95
  s_waitcnt vmcnt(10)
  s_barrier
  s_add_u32 m0, s7, 24576
  ds_read_b128 v[48:51], v2 offset:12288
  s_waitcnt lgkmcnt(3)
  v_mfma_f32_32x32x16_bf16 v[32:47], v[52:55], v[148:151], v[32:47]
  v_cvt_pk_bf16_f32 v76, v80, v81
  v_cvt_pk_bf16_f32 v77, v82, v83
  v_cvt_pk_bf16_f32 v78, v84, v85
  v_cvt_pk_bf16_f32 v79, v86, v87
  buffer_load_dwordx4 v1, s[16:19], s28 offen offset:0 lds
  ds_read_b128 v[52:55], v2 offset:13312
  s_waitcnt lgkmcnt(3)
  v_mfma_f32_32x32x16_bf16 v[32:47], v[56:59], v[152:155], v[32:47]
  ds_read_b128 v[56:59], v2 offset:14336
  s_waitcnt lgkmcnt(3)
  v_mfma_f32_32x32x16_bf16 v[32:47], v[60:63], v[156:159], v[32:47]
  buffer_store_dwordx4 v[76:79], v1, s[24:27], s37 offen sc1
  s_add_u32 s30, s30, s36
  s_mov_b32 s36, 1024
  s_mov_b32 s37, s30
  ds_read_b128 v[60:63], v2 offset:15360
  s_waitcnt lgkmcnt(3)
  v_mfma_f32_32x32x16_bf16 v[32:47], v[48:51], v[160:163], v[32:47]
  ds_read_b128 v[48:51], v2 offset:16384
  s_waitcnt lgkmcnt(3)
  v_mfma_f32_32x32x16_bf16 v[32:47], v[52:55], v[164:167], v[32:47]
  buffer_load_dwordx4 v1, s[16:19], s28 offen offset:1024 lds
  ds_read_b128 v[52:55], v2 offset:17408
  s_waitcnt lgkmcnt(3)
  v_mfma_f32_32x32x16_bf16 v[32:47], v[56:59], v[168:171], v[32:47]
  ds_read_b128 v[56:59], v2 offset:18432
  s_waitcnt lgkmcnt(3)
  v_mfma_f32_32x32x16_bf16 v[32:47], v[60:63], v[172:175], v[32:47]
  ds_read_b128 v[60:63], v2 offset:19456
  s_waitcnt lgkmcnt(3)
  v_mfma_f32_32x32x16_bf16 v[32:47], v[48:51], v[176:179], v[32:47]
  ds_read_b128 v[48:51], v2 offset:20480
  s_waitcnt lgkmcnt(3)
  v_mfma_f32_32x32x16_bf16 v[32:47], v[52:55], v[180:183], v[32:47]
  buffer_load_dwordx4 v1, s[16:19], s28 offen offset:2048 lds
  s_add_u32 s28, s28, 12288
  ds_read_b128 v[52:55], v2 offset:21504
  s_waitcnt lgkmcnt(3)
  v_mfma_f32_32x32x16_bf16 v[32:47], v[56:59], v[184:187], v[32:47]
  ds_read_b128 v[56:59], v2 offset:22528
  s_waitcnt lgkmcnt(3)
  v_mfma_f32_32x32x16_bf16 v[32:47], v[60:63], v[188:191], v[32:47]
  ds_read_b128 v[60:63], v2 offset:23552
  s_waitcnt lgkmcnt(3)
  v_mfma_f32_32x32x16_bf16 v[32:47], v[48:51], v[192:195], v[32:47]
  s_waitcnt vmcnt(10)
  s_barrier
  s_add_u32 m0, s7, 36864
  s_mov_b64 exec, 1
  buffer_atomic_add v99, v98, s[40:43], s44 offen
  s_mov_b64 exec, -1
  s_add_u32 s44, s44, s45
  s_mov_b32 s45, 128
  v_mov_b32 v99, 1
  ds_read_b128 v[48:51], v2 offset:24576
  s_waitcnt lgkmcnt(3)
  v_mfma_f32_32x32x16_bf16 v[32:47], v[52:55], v[196:199], v[32:47]
  buffer_load_dwordx4 v1, s[16:19], s28 offen offset:0 lds
  ds_read_b128 v[52:55], v2 offset:25600
  s_waitcnt lgkmcnt(3)
  v_mfma_f32_32x32x16_bf16 v[32:47], v[56:59], v[200:203], v[32:47]
  ds_read_b128 v[56:59], v2 offset:26624
  s_waitcnt lgkmcnt(3)
  v_mfma_f32_32x32x16_bf16 v[32:47], v[60:63], v[204:207], v[32:47]
  ds_read_b128 v[60:63], v2 offset:27648
  s_waitcnt lgkmcnt(3)
  v_mfma_f32_32x32x16_bf16 v[32:47], v[48:51], v[208:211], v[32:47]
  ds_read_b128 v[48:51], v2 offset:28672
  s_waitcnt lgkmcnt(3)
  v_mfma_f32_32x32x16_bf16 v[32:47], v[52:55], v[212:215], v[32:47]
  buffer_load_dwordx4 v1, s[16:19], s28 offen offset:1024 lds
  ds_read_b128 v[52:55], v2 offset:29696
  s_waitcnt lgkmcnt(3)
  v_mfma_f32_32x32x16_bf16 v[32:47], v[56:59], v[216:219], v[32:47]
  ds_read_b128 v[56:59], v2 offset:30720
  s_waitcnt lgkmcnt(3)
  v_mfma_f32_32x32x16_bf16 v[32:47], v[60:63], v[220:223], v[32:47]
  ds_read_b128 v[60:63], v2 offset:31744
  s_waitcnt lgkmcnt(3)
  v_mfma_f32_32x32x16_bf16 v[32:47], v[48:51], v[224:227], v[32:47]
  ds_read_b128 v[48:51], v2 offset:32768
  s_waitcnt lgkmcnt(3)
  v_mfma_f32_32x32x16_bf16 v[32:47], v[52:55], v[228:231], v[32:47]
  buffer_load_dwordx4 v1, s[16:19], s28 offen offset:2048 lds
  s_add_u32 s28, s28, 12288
  ds_read_b64 v[64:65], v15 offset:512
  v_add_u32 v15, 512, v15
  ds_read_b128 v[52:55], v2 offset:33792
  s_waitcnt lgkmcnt(3)
  v_mfma_f32_32x32x16_bf16 v[32:47], v[56:59], v[232:235], v[32:47]
  ds_read_b128 v[56:59], v2 offset:34816
  s_waitcnt lgkmcnt(3)
  v_mfma_f32_32x32x16_bf16 v[32:47], v[60:63], v[236:239], v[32:47]
  ds_read_b128 v[60:63], v2 offset:35840
  s_waitcnt lgkmcnt(3)
  v_mfma_f32_32x32x16_bf16 v[32:47], v[48:51], v[240:243], v[32:47]
  s_waitcnt vmcnt(11)
  s_barrier
  s_add_u32 m0, s7, 49152
  ds_read_b128 v[48:51], v1 offset:0
  s_waitcnt lgkmcnt(3)
  v_mfma_f32_32x32x16_bf16 v[32:47], v[52:55], v[244:247], v[32:47]
  buffer_load_dwordx4 v1, s[16:19], s28 offen offset:0 lds
  ds_read_b128 v[52:55], v1 offset:1024
  s_waitcnt lgkmcnt(3)
  v_mfma_f32_32x32x16_bf16 v[32:47], v[56:59], v[248:251], v[32:47]
  ds_read_b128 v[56:59], v1 offset:2048
  s_waitcnt lgkmcnt(3)
  v_mfma_f32_32x32x16_bf16 v[32:47], v[60:63], v[252:255], v[32:47]
  s_add_u32 s32, s32, 1
  s_cmp_lt_u32 s32, 9
  s_cbranch_scc1 gemm12_kernel_loop1
  s_nop 15
  v_max_f32 v80, 0, v32
  v_mul_f32 v88, v36, v96
  v_mul_f32 v80, v80, v88
  v_max_f32 v81, 0, v33
  v_mul_f32 v89, v37, v96
  v_mul_f32 v81, v81, v89
  v_max_f32 v82, 0, v34
  v_mul_f32 v90, v38, v96
  v_mul_f32 v82, v82, v90
  v_max_f32 v83, 0, v35
  v_mul_f32 v91, v39, v96
  v_mul_f32 v83, v83, v91
  v_max_f32 v84, 0, v40
  v_mul_f32 v92, v44, v96
  v_mul_f32 v84, v84, v92
  v_max_f32 v85, 0, v41
  v_mul_f32 v93, v45, v96
  v_mul_f32 v85, v85, v93
  v_max_f32 v86, 0, v42
  v_mul_f32 v94, v46, v96
  v_mul_f32 v86, v86, v94
  v_max_f32 v87, 0, v43
  v_mul_f32 v95, v47, v96
  v_mul_f32 v87, v87, v95
  v_cvt_pk_bf16_f32 v76, v80, v81
  v_cvt_pk_bf16_f32 v77, v82, v83
  v_cvt_pk_bf16_f32 v78, v84, v85
  v_cvt_pk_bf16_f32 v79, v86, v87
  buffer_store_dwordx4 v[76:79], v1, s[24:27], s30 offen sc1
  s_waitcnt vmcnt(0)
  s_mov_b64 exec, 1
  buffer_atomic_add v99, v98, s[40:43], s44 offen
  s_mov_b64 exec, -1
  s_branch gemm12_kernel_fin
gemm12_kernel_r2:
  s_sub_u32 s2, s2, 256
  s_load_dwordx2 s[10:11], s[0:1], 104
  s_load_dwordx2 s[8:9], s[0:1], 88
  v_and_b32 v227, 63, v0
  v_lshrrev_b32 v230, 6, v0
  s_and_b32 s4, s2, 7
  s_lshl_b32 s4, s4, 2
  s_bfe_u32 s5, s2, 0x20003
  s_add_u32 s4, s4, s5
  s_lshr_b32 s5, s2, 5
  v_readfirstlane_b32 s3, v230
  v_lshlrev_b32 v225, 4, v227
  v_lshrrev_b32 v230, 4, v227
  v_and_b32 v231, 7, v227
  v_lshl_add_u32 v230, v230, 3, v231
  v_lshlrev_b32 v230, 4, v230
  v_add_u32 v226, 4096, v230
  s_mul_i32 s30, s5, 144
  s_mul_i32 s6, s3, 9
  s_add_u32 s30, s30, s6
  s_mul_i32 s30, s30, 4608
  s_waitcnt lgkmcnt(0)
  s_add_u32 s16, s10, 11010048
  s_addc_u32 s17, s11, 0
  s_and_b32 s17, s17, 0xffff
  s_mov_b32 s18, 5308416
  s_mov_b32 s19, 0x20000
  s_sleep 16
  s_sleep 16
  s_sleep 16
  s_sleep 16
  s_add_u32 s31, s30, 0
  buffer_load_dwordx4 v[80:83], v225, s[16:19], s31 offen offset:0
  buffer_load_dwordx4 v[84:87], v225, s[16:19], s31 offen offset:1024
  buffer_load_dwordx4 v[88:91], v225, s[16:19], s31 offen offset:2048
  buffer_load_dwordx4 v[92:95], v225, s[16:19], s31 offen offset:3072
  buffer_load_dwordx4 v[96:99], v226, s[16:19], s31 offen
  s_add_u32 s31, s30, 165888
  buffer_load_dwordx4 v[116:119], v225, s[16:19], s31 offen offset:0
  buffer_load_dwordx4 v[120:123], v225, s[16:19], s31 offen offset:1024
  buffer_load_dwordx4 v[124:127], v225, s[16:19], s31 offen offset:2048
  buffer_load_dwordx4 v[128:131], v225, s[16:19], s31 offen offset:3072
  buffer_load_dwordx4 v[132:135], v226, s[16:19], s31 offen
  s_add_u32 s31, s30, 331776
  buffer_load_dwordx4 v[152:155], v225, s[16:19], s31 offen offset:0
  buffer_load_dwordx4 v[156:159], v225, s[16:19], s31 offen offset:1024
  buffer_load_dwordx4 v[160:163], v225, s[16:19], s31 offen offset:2048
  buffer_load_dwordx4 v[164:167], v225, s[16:19], s31 offen offset:3072
  buffer_load_dwordx4 v[168:171], v226, s[16:19], s31 offen
  s_add_u32 s31, s30, 497664
  buffer_load_dwordx4 v[188:191], v225, s[16:19], s31 offen offset:0
  buffer_load_dwordx4 v[192:195], v225, s[16:19], s31 offen offset:1024
  buffer_load_dwordx4 v[196:199], v225, s[16:19], s31 offen offset:2048
  buffer_load_dwordx4 v[200:203], v225, s[16:19], s31 offen offset:3072
  buffer_load_dwordx4 v[204:207], v226, s[16:19], s31 offen
  s_cmp_ge_u32 s2, 8
  s_cbranch_scc1 gemm12_kernel_nopf
  s_getpc_b64 s[94:95]
gemm12_kernel_pfpc:
  s_sub_u32 s94, s94, gemm12_kernel_pfpc-gemm12_kernel
  s_subb_u32 s95, s95, 0
  v_lshlrev_b32 v253, 7, v0
  v_min_u32 v253, all_code_end-gemm12_kernel-4, v253
  global_load_dword v254, v253, s[94:95]
gemm12_kernel_nopf:
  s_add_u32 s12, s10, 33554432
  s_addc_u32 s13, s11, 0
  s_and_b32 s13, s13, 0xffff
  s_mov_b32 s14, 18874368
  s_mov_b32 s15, 0x20000
  s_add_u32 s20, s10, 16777216
  s_addc_u32 s21, s11, 0
  s_and_b32 s21, s21, 0xffff
  s_mov_b32 s22, 2359296
  s_mov_b32 s23, 0x20000
  s_mov_b32 s24, s8
  s_and_b32 s25, s9, 0xffff
  s_mov_b32 s26, 2359296
  s_mov_b32 s27, 0x20000
  s_add_u32 s40, s10, 24182784
  s_addc_u32 s41, s11, 0
  s_and_b32 s41, s41, 0xffff
  s_mov_b32 s42, 36864
  s_mov_b32 s43, 0x20000
  v_lshrrev_b32 v230, 5, v227
  v_lshlrev_b32 v230, 10, v230
  v_bfe_u32 v231, v227, 4, 1
  v_lshl_add_u32 v230, v231, 9, v230
  v_and_b32 v231, 15, v227
  v_lshl_add_u32 v224, v231, 4, v230
  v_mov_b32 v228, 0
  s_mul_i32 s28, s4, 2*288*1024
  s_mul_i32 s6, s3, 18*1024
  s_add_u32 s28, s28, s6
  s_add_u32 s6, s3, 0
  s_and_b32 s6, s6, 3
  s_lshr_b32 s7, s6, 1
  s_mul_i32 s7, s7, 294912
  s_and_b32 s6, s6, 1
  s_lshl_b32 s6, s6, 8
  s_add_u32 s44, s28, s7
  s_add_u32 s44, s44, s6
  s_add_u32 s6, s3, 1
  s_and_b32 s6, s6, 3
  s_lshr_b32 s7, s6, 1
  s_mul_i32 s7, s7, 294912
  s_and_b32 s6, s6, 1
  s_lshl_b32 s6, s6, 8
  s_add_u32 s45, s28, s7
  s_add_u32 s45, s45, s6
  s_add_u32 s6, s3, 2
  s_and_b32 s6, s6, 3
  s_lshr_b32 s7, s6, 1
  s_mul_i32 s7, s7, 294912
  s_and_b32 s6, s6, 1
  s_lshl_b32 s6, s6, 8
  s_add_u32 s46, s28, s7
  s_add_u32 s46, s46, s6
  s_add_u32 s6, s3, 3
  s_and_b32 s6, s6, 3
  s_lshr_b32 s7, s6, 1
  s_mul_i32 s7, s7, 294912
  s_and_b32 s6, s6, 1
  s_lshl_b32 s6, s6, 8
  s_add_u32 s47, s28, s7
  s_add_u32 s47, s47, s6
  s_mul_i32 s48, s4, 9*128
  v_mov_b32 v0, 0
  v_mov_b32 v1, 0
  v_mov_b32 v2, 0
  v_mov_b32 v3, 0
  v_mov_b32 v4, 0
  v_mov_b32 v5, 0
  v_mov_b32 v6, 0
  v_mov_b32 v7, 0
  v_mov_b32 v8, 0
  v_mov_b32 v9, 0
  v_mov_b32 v10, 0
  v_mov_b32 v11, 0
  v_mov_b32 v12, 0
  v_mov_b32 v13, 0
  v_mov_b32 v14, 0
  v_mov_b32 v15, 0
  v_mov_b32 v16, 0
  v_mov_b32 v17, 0
  v_mov_b32 v18, 0
  v_mov_b32 v19, 0
  v_mov_b32 v20, 0
  v_mov_b32 v21, 0
  v_mov_b32 v22, 0
  v_mov_b32 v23, 0
  v_mov_b32 v24, 0
  v_mov_b32 v25, 0
  v_mov_b32 v26, 0
  v_mov_b32 v27, 0
  v_mov_b32 v28, 0
  v_mov_b32 v29, 0
  v_mov_b32 v30, 0
  v_mov_b32 v31, 0
  v_mov_b32 v32, 0
  v_mov_b32 v33, 0
  v_mov_b32 v34, 0
  v_mov_b32 v35, 0
  v_mov_b32 v36, 0
  v_mov_b32 v37, 0
  v_mov_b32 v38, 0
  v_mov_b32 v39, 0
  v_mov_b32 v40, 0
  v_mov_b32 v41, 0
  v_mov_b32 v42, 0
  v_mov_b32 v43, 0
  v_mov_b32 v44, 0
  v_mov_b32 v45, 0
  v_mov_b32 v46, 0
  v_mov_b32 v47, 0
  v_mov_b32 v48, 0
  v_mov_b32 v49, 0
  v_mov_b32 v50, 0
  v_mov_b32 v51, 0
  v_mov_b32 v52, 0
  v_mov_b32 v53, 0
  v_mov_b32 v54, 0
  v_mov_b32 v55, 0
  v_mov_b32 v56, 0
  v_mov_b32 v57, 0
  v_mov_b32 v58, 0
  v_mov_b32 v59, 0
  v_mov_b32 v60, 0
  v_mov_b32 v61, 0
  v_mov_b32 v62, 0
  v_mov_b32 v63, 0
  v_mov_b32 v64, 0
  v_mov_b32 v65, 0
  v_mov_b32 v66, 0
  v_mov_b32 v67, 0
  v_mov_b32 v68, 0
  v_mov_b32 v69, 0
  v_mov_b32 v70, 0
  v_mov_b32 v71, 0
  v_mov_b32 v72, 0
  v_mov_b32 v73, 0
  v_mov_b32 v74, 0
  v_mov_b32 v75, 0
  v_mov_b32 v76, 0
  v_mov_b32 v77, 0
  v_mov_b32 v78, 0
  v_mov_b32 v79, 0
  v_and_b32 v251, 3, v227
  v_lshlrev_b32 v251, 4, v251
  s_lshl_b32 s6, s3, 2
  v_add_u32 v251, s6, v251
  v_and_b32 v228, 15, v227
  v_lshlrev_b32 v228, 2, v228
  v_lshrrev_b32 v230, 4, v227
  v_lshlrev_b32 v230, 2, v230
  s_mul_i32 s33, s5, 72
  v_add_u32 v230, s33, v230
  v_lshrrev_b32 v231, 4, v230
  v_lshlrev_b32 v231, 10, v231
  v_bfe_u32 v232, v230, 3, 1
  v_lshl_add_u32 v231, v232, 9, v231
  v_and_b32 v232, 7, v230
  v_lshl_add_u32 v231, v232, 1, v231
  v_and_b32 v232, 15, v227
  s_and_b32 s34, s3, 1
  s_lshl_b32 s34, s34, 4
  v_add_u32 v232, s34, v232
  v_lshl_add_u32 v230, v232, 4, v231
  s_lshl_b32 s33, s4, 1
  s_lshr_b32 s34, s3, 1
  s_add_u32 s33, s33, s34
  s_mul_i32 s33, s33, 36864
  buffer_load_dwordx2 v[236:237], v230, s[20:23], s33 offen offset:0
  buffer_load_dwordx2 v[238:239], v230, s[20:23], s33 offen offset:1024
  buffer_load_dwordx2 v[240:241], v230, s[20:23], s33 offen offset:2048
  buffer_load_dwordx2 v[242:243], v230, s[20:23], s33 offen offset:3072
  s_add_u32 s33, s33, 4096
  buffer_load_dwordx2 v[244:245], v230, s[20:23], s33 offen offset:0
  s_mul_i32 s35, s3, 15360
  v_add_u32 v232, s35, v225
  v_and_b32 v233, 15, v227
  s_lshl_b32 s34, s4, 6
  s_lshl_b32 s35, s3, 4
  s_add_u32 s34, s34, s35
  v_add_u32 v233, s34, v233
  v_mul_u32_u24 v233, 1152, v233
  v_lshrrev_b32 v234, 4, v227
  v_lshl_add_u32 v233, v234, 3, v233
  s_mul_i32 s34, s5, 144
  v_add_u32 v233, s34, v233
  v_cmp_gt_u32 vcc, 32, v227
  v_mov_b32 v234, 0x7fffffff
  s_add_u32 s34, s3, 1
  s_and_b32 s34, s34, 3
  s_mul_i32 s35, s34, 15360
  s_add_u32 s53, s35, 0
  s_add_u32 s34, s3, 2
  s_and_b32 s34, s34, 3
  s_mul_i32 s35, s34, 15360
  s_add_u32 s54, s35, 5120
  s_add_u32 s34, s3, 3
  s_and_b32 s34, s34, 3
  s_mul_i32 s35, s34, 15360
  s_add_u32 s55, s35, 10240
  v_cndmask_b32 v234, v234, v233, vcc
  s_cmp_lg_u32 s3, 0
  s_cbranch_scc1 gemm12_kernel_spun0
  s_mov_b32 s35, 200000
gemm12_kernel_spin0:
  buffer_load_dword v252, v228, s[40:43], s48 offen sc1
  s_waitcnt vmcnt(0)
  v_cmp_le_u32 vcc, 2, v252
  s_cmp_eq_u64 vcc, -1
  s_cbranch_scc1 gemm12_kernel_spun0
  s_sleep 16
  s_sub_u32 s35, s35, 1
  s_cmp_lg_u32 s35, 0
  s_cbranch_scc1 gemm12_kernel_spin0
gemm12_kernel_spun0:
  s_barrier
  s_add_u32 s33, s44, 0
  buffer_load_dwordx4 v[100:103], v224, s[12:15], s33 offen sc1
  s_add_u32 s33, s45, 0
  buffer_load_dwordx4 v[104:107], v224, s[12:15], s33 offen sc1
  s_add_u32 s33, s46, 0
  buffer_load_dwordx4 v[108:111], v224, s[12:15], s33 offen sc1
  s_add_u32 s33, s47, 0
  buffer_load_dwordx4 v[112:115], v224, s[12:15], s33 offen sc1
  s_add_u32 s33, s44, 73728
  buffer_load_dwordx4 v[136:139], v224, s[12:15], s33 offen sc1
  s_add_u32 s33, s45, 73728
  buffer_load_dwordx4 v[140:143], v224, s[12:15], s33 offen sc1
  s_add_u32 s33, s46, 73728
  buffer_load_dwordx4 v[144:147], v224, s[12:15], s33 offen sc1
  s_add_u32 s33, s47, 73728
  buffer_load_dwordx4 v[148:151], v224, s[12:15], s33 offen sc1
  s_add_u32 s33, s44, 147456
  buffer_load_dwordx4 v[172:175], v224, s[12:15], s33 offen sc1
  s_add_u32 s33, s45, 147456
  buffer_load_dwordx4 v[176:179], v224, s[12:15], s33 offen sc1
  s_add_u32 s33, s46, 147456
  buffer_load_dwordx4 v[180:183], v224, s[12:15], s33 offen sc1
  s_add_u32 s33, s47, 147456
  buffer_load_dwordx4 v[184:187], v224, s[12:15], s33 offen sc1
  s_add_u32 s33, s44, 221184
  buffer_load_dwordx4 v[208:211], v224, s[12:15], s33 offen sc1
  s_add_u32 s33, s45, 221184
  buffer_load_dwordx4 v[212:215], v224, s[12:15], s33 offen sc1
  s_add_u32 s33, s46, 221184
  buffer_load_dwordx4 v[216:219], v224, s[12:15], s33 offen sc1
  s_add_u32 s33, s47, 221184
  buffer_load_dwordx4 v[220:223], v224, s[12:15], s33 offen sc1
  s_add_u32 s44, s44, 2048
  s_add_u32 s45, s45, 2048
  s_add_u32 s46, s46, 2048
  s_add_u32 s47, s47, 2048
  s_add_u32 s30, s30, 4608
  s_add_u32 s48, s48, 128
  buffer_load_dword v229, v251, s[40:43], s48 offen sc1
  s_waitcnt vmcnt(0)
  s_mov_b32 s32, 0
gemm12_kernel_loop2:
  s_waitcnt vmcnt(28)
  buffer_load_dword v250, v251, s[40:43], s48 offen sc1
  s_add_u32 s31, s30, 0
  v_mfma_f32_16x16x32_bf16 v[0:3], v[80:83], v[100:103], v[0:3]
  v_mfma_f32_16x16x32_bf16 v[4:7], v[80:83], v[104:107], v[4:7]
  v_mfma_f32_16x16x32_bf16 v[8:11], v[80:83], v[108:111], v[8:11]
  v_mfma_f32_16x16x32_bf16 v[12:15], v[80:83], v[112:115], v[12:15]
  buffer_load_dwordx4 v[80:83], v225, s[16:19], s31 offen offset:0
  v_mfma_f32_16x16x32_bf16 v[16:19], v[84:87], v[100:103], v[16:19]
  v_mfma_f32_16x16x32_bf16 v[20:23], v[84:87], v[104:107], v[20:23]
  v_mfma_f32_16x16x32_bf16 v[24:27], v[84:87], v[108:111], v[24:27]
  v_mfma_f32_16x16x32_bf16 v[28:31], v[84:87], v[112:115], v[28:31]
  buffer_load_dwordx4 v[84:87], v225, s[16:19], s31 offen offset:1024
  v_mfma_f32_16x16x32_bf16 v[32:35], v[88:91], v[100:103], v[32:35]
  v_mfma_f32_16x16x32_bf16 v[36:39], v[88:91], v[104:107], v[36:39]
  v_mfma_f32_16x16x32_bf16 v[40:43], v[88:91], v[108:111], v[40:43]
  v_mfma_f32_16x16x32_bf16 v[44:47], v[88:91], v[112:115], v[44:47]
  buffer_load_dwordx4 v[88:91], v225, s[16:19], s31 offen offset:2048
  v_mfma_f32_16x16x32_bf16 v[48:51], v[92:95], v[100:103], v[48:51]
  v_mfma_f32_16x16x32_bf16 v[52:55], v[92:95], v[104:107], v[52:55]
  v_mfma_f32_16x16x32_bf16 v[56:59], v[92:95], v[108:111], v[56:59]
  v_mfma_f32_16x16x32_bf16 v[60:63], v[92:95], v[112:115], v[60:63]
  buffer_load_dwordx4 v[92:95], v225, s[16:19], s31 offen offset:3072
  v_mfma_f32_16x16x32_bf16 v[64:67], v[96:99], v[100:103], v[64:67]
  v_mfma_f32_16x16x32_bf16 v[68:71], v[96:99], v[104:107], v[68:71]
  v_mfma_f32_16x16x32_bf16 v[72:75], v[96:99], v[108:111], v[72:75]
  v_mfma_f32_16x16x32_bf16 v[76:79], v[96:99], v[112:115], v[76:79]
  buffer_load_dwordx4 v[96:99], v226, s[16:19], s31 offen
  s_waitcnt vmcnt(24)
  v_cmp_le_u32 vcc, 2, v229
  s_bitcmp1_b32 vcc_lo, 0
  s_cbranch_scc1 gemm12_kernel_g0
  s_mov_b32 s35, 200000
gemm12_kernel_gs0:
  buffer_load_dword v252, v251, s[40:43], s48 offen sc1
  s_waitcnt vmcnt(0)
  v_cmp_le_u32 vcc, 2, v252
  s_bitcmp1_b32 vcc_lo, 0
  s_cbranch_scc1 gemm12_kernel_g0
  s_sleep 8
  s_sub_u32 s35, s35, 1
  s_cmp_lg_u32 s35, 0
  s_cbranch_scc1 gemm12_kernel_gs0
gemm12_kernel_g0:
  s_add_u32 s33, s44, 0
  buffer_load_dwordx4 v[100:103], v224, s[12:15], s33 offen sc1
  s_add_u32 s33, s45, 0
  buffer_load_dwordx4 v[104:107], v224, s[12:15], s33 offen sc1
  s_add_u32 s33, s46, 0
  buffer_load_dwordx4 v[108:111], v224, s[12:15], s33 offen sc1
  s_add_u32 s33, s47, 0
  buffer_load_dwordx4 v[112:115], v224, s[12:15], s33 offen sc1
  s_add_u32 s31, s30, 165888
  v_mfma_f32_16x16x32_bf16 v[0:3], v[116:119], v[136:139], v[0:3]
  v_mfma_f32_16x16x32_bf16 v[4:7], v[116:119], v[140:143], v[4:7]
  v_mfma_f32_16x16x32_bf16 v[8:11], v[116:119], v[144:147], v[8:11]
  v_mfma_f32_16x16x32_bf16 v[12:15], v[116:119], v[148:151], v[12:15]
  buffer_load_dwordx4 v[116:119], v225, s[16:19], s31 offen offset:0
  v_mfma_f32_16x16x32_bf16 v[16:19], v[120:123], v[136:139], v[16:19]
  v_mfma_f32_16x16x32_bf16 v[20:23], v[120:123], v[140:143], v[20:23]
  v_mfma_f32_16x16x32_bf16 v[24:27], v[120:123], v[144:147], v[24:27]
  v_mfma_f32_16x16x32_bf16 v[28:31], v[120:123], v[148:151], v[28:31]
  buffer_load_dwordx4 v[120:123], v225, s[16:19], s31 offen offset:1024
  v_mfma_f32_16x16x32_bf16 v[32:35], v[124:127], v[136:139], v[32:35]
  v_mfma_f32_16x16x32_bf16 v[36:39], v[124:127], v[140:143], v[36:39]
  v_mfma_f32_16x16x32_bf16 v[40:43], v[124:127], v[144:147], v[40:43]
  v_mfma_f32_16x16x32_bf16 v[44:47], v[124:127], v[148:151], v[44:47]
  buffer_load_dwordx4 v[124:127], v225, s[16:19], s31 offen offset:2048
  v_mfma_f32_16x16x32_bf16 v[48:51], v[128:131], v[136:139], v[48:51]
  v_mfma_f32_16x16x32_bf16 v[52:55], v[128:131], v[140:143], v[52:55]
  v_mfma_f32_16x16x32_bf16 v[56:59], v[128:131], v[144:147], v[56:59]
  v_mfma_f32_16x16x32_bf16 v[60:63], v[128:131], v[148:151], v[60:63]
  buffer_load_dwordx4 v[128:131], v225, s[16:19], s31 offen offset:3072
  v_mfma_f32_16x16x32_bf16 v[64:67], v[132:135], v[136:139], v[64:67]
  v_mfma_f32_16x16x32_bf16 v[68:71], v[132:135], v[140:143], v[68:71]
  v_mfma_f32_16x16x32_bf16 v[72:75], v[132:135], v[144:147], v[72:75]
  v_mfma_f32_16x16x32_bf16 v[76:79], v[132:135], v[148:151], v[76:79]
  buffer_load_dwordx4 v[132:135], v226, s[16:19], s31 offen
  v_cmp_le_u32 vcc, 2, v229
  s_bitcmp1_b32 vcc_lo, 1
  s_cbranch_scc1 gemm12_kernel_g1
  s_mov_b32 s35, 200000
gemm12_kernel_gs1:
  buffer_load_dword v252, v251, s[40:43], s48 offen sc1
  s_waitcnt vmcnt(0)
  v_cmp_le_u32 vcc, 2, v252
  s_bitcmp1_b32 vcc_lo, 1
  s_cbranch_scc1 gemm12_kernel_g1
  s_sleep 8
  s_sub_u32 s35, s35, 1
  s_cmp_lg_u32 s35, 0
  s_cbranch_scc1 gemm12_kernel_gs1
gemm12_kernel_g1:
  s_add_u32 s33, s44, 73728
  buffer_load_dwordx4 v[136:139], v224, s[12:15], s33 offen sc1
  s_add_u32 s33, s45, 73728
  buffer_load_dwordx4 v[140:143], v224, s[12:15], s33 offen sc1
  s_add_u32 s33, s46, 73728
  buffer_load_dwordx4 v[144:147], v224, s[12:15], s33 offen sc1
  s_add_u32 s33, s47, 73728
  buffer_load_dwordx4 v[148:151], v224, s[12:15], s33 offen sc1
  s_waitcnt vmcnt(28)
  s_add_u32 s49, s48, 128
  buffer_load_dword v229, v251, s[40:43], s49 offen sc1
  s_add_u32 s31, s30, 331776
  v_mfma_f32_16x16x32_bf16 v[0:3], v[152:155], v[172:175], v[0:3]
  v_mfma_f32_16x16x32_bf16 v[4:7], v[152:155], v[176:179], v[4:7]
  v_mfma_f32_16x16x32_bf16 v[8:11], v[152:155], v[180:183], v[8:11]
  v_mfma_f32_16x16x32_bf16 v[12:15], v[152:155], v[184:187], v[12:15]
  buffer_load_dwordx4 v[152:155], v225, s[16:19], s31 offen offset:0
  v_mfma_f32_16x16x32_bf16 v[16:19], v[156:159], v[172:175], v[16:19]
  v_mfma_f32_16x16x32_bf16 v[20:23], v[156:159], v[176:179], v[20:23]
  v_mfma_f32_16x16x32_bf16 v[24:27], v[156:159], v[180:183], v[24:27]
  v_mfma_f32_16x16x32_bf16 v[28:31], v[156:159], v[184:187], v[28:31]
  buffer_load_dwordx4 v[156:159], v225, s[16:19], s31 offen offset:1024
  v_mfma_f32_16x16x32_bf16 v[32:35], v[160:163], v[172:175], v[32:35]
  v_mfma_f32_16x16x32_bf16 v[36:39], v[160:163], v[176:179], v[36:39]
  v_mfma_f32_16x16x32_bf16 v[40:43], v[160:163], v[180:183], v[40:43]
  v_mfma_f32_16x16x32_bf16 v[44:47], v[160:163], v[184:187], v[44:47]
  buffer_load_dwordx4 v[160:163], v225, s[16:19], s31 offen offset:2048
  v_mfma_f32_16x16x32_bf16 v[48:51], v[164:167], v[172:175], v[48:51]
  v_mfma_f32_16x16x32_bf16 v[52:55], v[164:167], v[176:179], v[52:55]
  v_mfma_f32_16x16x32_bf16 v[56:59], v[164:167], v[180:183], v[56:59]
  v_mfma_f32_16x16x32_bf16 v[60:63], v[164:167], v[184:187], v[60:63]
  buffer_load_dwordx4 v[164:167], v225, s[16:19], s31 offen offset:3072
  v_mfma_f32_16x16x32_bf16 v[64:67], v[168:171], v[172:175], v[64:67]
  v_mfma_f32_16x16x32_bf16 v[68:71], v[168:171], v[176:179], v[68:71]
  v_mfma_f32_16x16x32_bf16 v[72:75], v[168:171], v[180:183], v[72:75]
  v_mfma_f32_16x16x32_bf16 v[76:79], v[168:171], v[184:187], v[76:79]
  buffer_load_dwordx4 v[168:171], v226, s[16:19], s31 offen
  s_waitcnt vmcnt(24)
  v_cmp_le_u32 vcc, 2, v250
  s_bitcmp1_b32 vcc_lo, 2
  s_cbranch_scc1 gemm12_kernel_g2
  s_mov_b32 s35, 200000
gemm12_kernel_gs2:
  buffer_load_dword v252, v251, s[40:43], s48 offen sc1
  s_waitcnt vmcnt(0)
  v_cmp_le_u32 vcc, 2, v252
  s_bitcmp1_b32 vcc_lo, 2
  s_cbranch_scc1 gemm12_kernel_g2
  s_sleep 8
  s_sub_u32 s35, s35, 1
  s_cmp_lg_u32 s35, 0
  s_cbranch_scc1 gemm12_kernel_gs2
gemm12_kernel_g2:
  s_add_u32 s33, s44, 147456
  buffer_load_dwordx4 v[172:175], v224, s[12:15], s33 offen sc1
  s_add_u32 s33, s45, 147456
  buffer_load_dwordx4 v[176:179], v224, s[12:15], s33 offen sc1
  s_add_u32 s33, s46, 147456
  buffer_load_dwordx4 v[180:183], v224, s[12:15], s33 offen sc1
  s_add_u32 s33, s47, 147456
  buffer_load_dwordx4 v[184:187], v224, s[12:15], s33 offen sc1
  s_add_u32 s31, s30, 497664
  v_mfma_f32_16x16x32_bf16 v[0:3], v[188:191], v[208:211], v[0:3]
  v_mfma_f32_16x16x32_bf16 v[4:7], v[188:191], v[212:215], v[4:7]
  v_mfma_f32_16x16x32_bf16 v[8:11], v[188:191], v[216:219], v[8:11]
  v_mfma_f32_16x16x32_bf16 v[12:15], v[188:191], v[220:223], v[12:15]
  buffer_load_dwordx4 v[188:191], v225, s[16:19], s31 offen offset:0
  v_mfma_f32_16x16x32_bf16 v[16:19], v[192:195], v[208:211], v[16:19]
  v_mfma_f32_16x16x32_bf16 v[20:23], v[192:195], v[212:215], v[20:23]
  v_mfma_f32_16x16x32_bf16 v[24:27], v[192:195], v[216:219], v[24:27]
  v_mfma_f32_16x16x32_bf16 v[28:31], v[192:195], v[220:223], v[28:31]
  buffer_load_dwordx4 v[192:195], v225, s[16:19], s31 offen offset:1024
  v_mfma_f32_16x16x32_bf16 v[32:35], v[196:199], v[208:211], v[32:35]
  v_mfma_f32_16x16x32_bf16 v[36:39], v[196:199], v[212:215], v[36:39]
  v_mfma_f32_16x16x32_bf16 v[40:43], v[196:199], v[216:219], v[40:43]
  v_mfma_f32_16x16x32_bf16 v[44:47], v[196:199], v[220:223], v[44:47]
  buffer_load_dwordx4 v[196:199], v225, s[16:19], s31 offen offset:2048
  v_mfma_f32_16x16x32_bf16 v[48:51], v[200:203], v[208:211], v[48:51]
  v_mfma_f32_16x16x32_bf16 v[52:55], v[200:203], v[212:215], v[52:55]
  v_mfma_f32_16x16x32_bf16 v[56:59], v[200:203], v[216:219], v[56:59]
  v_mfma_f32_16x16x32_bf16 v[60:63], v[200:203], v[220:223], v[60:63]
  buffer_load_dwordx4 v[200:203], v225, s[16:19], s31 offen offset:3072
  v_mfma_f32_16x16x32_bf16 v[64:67], v[204:207], v[208:211], v[64:67]
  v_mfma_f32_16x16x32_bf16 v[68:71], v[204:207], v[212:215], v[68:71]
  v_mfma_f32_16x16x32_bf16 v[72:75], v[204:207], v[216:219], v[72:75]
  v_mfma_f32_16x16x32_bf16 v[76:79], v[204:207], v[220:223], v[76:79]
  buffer_load_dwordx4 v[204:207], v226, s[16:19], s31 offen
  v_cmp_le_u32 vcc, 2, v250
  s_bitcmp1_b32 vcc_lo, 3
  s_cbranch_scc1 gemm12_kernel_g3
  s_mov_b32 s35, 200000
gemm12_kernel_gs3:
  buffer_load_dword v252, v251, s[40:43], s48 offen sc1
  s_waitcnt vmcnt(0)
  v_cmp_le_u32 vcc, 2, v252
  s_bitcmp1_b32 vcc_lo, 3
  s_cbranch_scc1 gemm12_kernel_g3
  s_sleep 8
  s_sub_u32 s35, s35, 1
  s_cmp_lg_u32 s35, 0
  s_cbranch_scc1 gemm12_kernel_gs3
gemm12_kernel_g3:
  s_add_u32 s33, s44, 221184
  buffer_load_dwordx4 v[208:211], v224, s[12:15], s33 offen sc1
  s_add_u32 s33, s45, 221184
  buffer_load_dwordx4 v[212:215], v224, s[12:15], s33 offen sc1
  s_add_u32 s33, s46, 221184
  buffer_load_dwordx4 v[216:219], v224, s[12:15], s33 offen sc1
  s_add_u32 s33, s47, 221184
  buffer_load_dwordx4 v[220:223], v224, s[12:15], s33 offen sc1
  s_add_u32 s44, s44, 2048
  s_add_u32 s45, s45, 2048
  s_add_u32 s46, s46, 2048
  s_add_u32 s47, s47, 2048
  s_add_u32 s30, s30, 4608
  s_mov_b32 s48, s49
  s_add_u32 s32, s32, 1
  s_cmp_lt_u32 s32, 8
  s_cbranch_scc1 gemm12_kernel_loop2
  s_waitcnt vmcnt(27)
  v_mfma_f32_16x16x32_bf16 v[0:3], v[80:83], v[100:103], v[0:3]
  v_mfma_f32_16x16x32_bf16 v[4:7], v[80:83], v[104:107], v[4:7]
  v_mfma_f32_16x16x32_bf16 v[8:11], v[80:83], v[108:111], v[8:11]
  v_mfma_f32_16x16x32_bf16 v[12:15], v[80:83], v[112:115], v[12:15]
  v_mfma_f32_16x16x32_bf16 v[16:19], v[84:87], v[100:103], v[16:19]
  v_mfma_f32_16x16x32_bf16 v[20:23], v[84:87], v[104:107], v[20:23]
  v_mfma_f32_16x16x32_bf16 v[24:27], v[84:87], v[108:111], v[24:27]
  v_mfma_f32_16x16x32_bf16 v[28:31], v[84:87], v[112:115], v[28:31]
  v_mfma_f32_16x16x32_bf16 v[32:35], v[88:91], v[100:103], v[32:35]
  v_mfma_f32_16x16x32_bf16 v[36:39], v[88:91], v[104:107], v[36:39]
  v_mfma_f32_16x16x32_bf16 v[40:43], v[88:91], v[108:111], v[40:43]
  v_mfma_f32_16x16x32_bf16 v[44:47], v[88:91], v[112:115], v[44:47]
  v_mfma_f32_16x16x32_bf16 v[48:51], v[92:95], v[100:103], v[48:51]
  v_mfma_f32_16x16x32_bf16 v[52:55], v[92:95], v[104:107], v[52:55]
  v_mfma_f32_16x16x32_bf16 v[56:59], v[92:95], v[108:111], v[56:59]
  v_mfma_f32_16x16x32_bf16 v[60:63], v[92:95], v[112:115], v[60:63]
  v_mfma_f32_16x16x32_bf16 v[64:67], v[96:99], v[100:103], v[64:67]
  v_mfma_f32_16x16x32_bf16 v[68:71], v[96:99], v[104:107], v[68:71]
  v_mfma_f32_16x16x32_bf16 v[72:75], v[96:99], v[108:111], v[72:75]
  v_mfma_f32_16x16x32_bf16 v[76:79], v[96:99], v[112:115], v[76:79]
  s_waitcnt vmcnt(18)
  v_mfma_f32_16x16x32_bf16 v[0:3], v[116:119], v[136:139], v[0:3]
  v_mfma_f32_16x16x32_bf16 v[4:7], v[116:119], v[140:143], v[4:7]
  v_mfma_f32_16x16x32_bf16 v[8:11], v[116:119], v[144:147], v[8:11]
  v_mfma_f32_16x16x32_bf16 v[12:15], v[116:119], v[148:151], v[12:15]
  v_mfma_f32_16x16x32_bf16 v[16:19], v[120:123], v[136:139], v[16:19]
  v_mfma_f32_16x16x32_bf16 v[20:23], v[120:123], v[140:143], v[20:23]
  v_mfma_f32_16x16x32_bf16 v[24:27], v[120:123], v[144:147], v[24:27]
  v_mfma_f32_16x16x32_bf16 v[28:31], v[120:123], v[148:151], v[28:31]
  v_mfma_f32_16x16x32_bf16 v[32:35], v[124:127], v[136:139], v[32:35]
  v_mfma_f32_16x16x32_bf16 v[36:39], v[124:127], v[140:143], v[36:39]
  v_mfma_f32_16x16x32_bf16 v[40:43], v[124:127], v[144:147], v[40:43]
  v_mfma_f32_16x16x32_bf16 v[44:47], v[124:127], v[148:151], v[44:47]
  v_mfma_f32_16x16x32_bf16 v[48:51], v[128:131], v[136:139], v[48:51]
  v_mfma_f32_16x16x32_bf16 v[52:55], v[128:131], v[140:143], v[52:55]
  v_mfma_f32_16x16x32_bf16 v[56:59], v[128:131], v[144:147], v[56:59]
  v_mfma_f32_16x16x32_bf16 v[60:63], v[128:131], v[148:151], v[60:63]
  v_mfma_f32_16x16x32_bf16 v[64:67], v[132:135], v[136:139], v[64:67]
  v_mfma_f32_16x16x32_bf16 v[68:71], v[132:135], v[140:143], v[68:71]
  v_mfma_f32_16x16x32_bf16 v[72:75], v[132:135], v[144:147], v[72:75]
  v_mfma_f32_16x16x32_bf16 v[76:79], v[132:135], v[148:151], v[76:79]
  s_waitcnt vmcnt(9)
  v_mfma_f32_16x16x32_bf16 v[0:3], v[152:155], v[172:175], v[0:3]
  v_mfma_f32_16x16x32_bf16 v[4:7], v[152:155], v[176:179], v[4:7]
  v_mfma_f32_16x16x32_bf16 v[8:11], v[152:155], v[180:183], v[8:11]
  v_mfma_f32_16x16x32_bf16 v[12:15], v[152:155], v[184:187], v[12:15]
  v_mfma_f32_16x16x32_bf16 v[16:19], v[156:159], v[172:175], v[16:19]
  v_mfma_f32_16x16x32_bf16 v[20:23], v[156:159], v[176:179], v[20:23]
  v_mfma_f32_16x16x32_bf16 v[24:27], v[156:159], v[180:183], v[24:27]
  v_mfma_f32_16x16x32_bf16 v[28:31], v[156:159], v[184:187], v[28:31]
  v_mfma_f32_16x16x32_bf16 v[32:35], v[160:163], v[172:175], v[32:35]
  v_mfma_f32_16x16x32_bf16 v[36:39], v[160:163], v[176:179], v[36:39]
  v_mfma_f32_16x16x32_bf16 v[40:43], v[160:163], v[180:183], v[40:43]
  v_mfma_f32_16x16x32_bf16 v[44:47], v[160:163], v[184:187], v[44:47]
  v_mfma_f32_16x16x32_bf16 v[48:51], v[164:167], v[172:175], v[48:51]
  v_mfma_f32_16x16x32_bf16 v[52:55], v[164:167], v[176:179], v[52:55]
  v_mfma_f32_16x16x32_bf16 v[56:59], v[164:167], v[180:183], v[56:59]
  v_mfma_f32_16x16x32_bf16 v[60:63], v[164:167], v[184:187], v[60:63]
  v_mfma_f32_16x16x32_bf16 v[64:67], v[168:171], v[172:175], v[64:67]
  v_mfma_f32_16x16x32_bf16 v[68:71], v[168:171], v[176:179], v[68:71]
  v_mfma_f32_16x16x32_bf16 v[72:75], v[168:171], v[180:183], v[72:75]
  v_mfma_f32_16x16x32_bf16 v[76:79], v[168:171], v[184:187], v[76:79]
  s_waitcnt vmcnt(0)
  v_mfma_f32_16x16x32_bf16 v[0:3], v[188:191], v[208:211], v[0:3]
  v_mfma_f32_16x16x32_bf16 v[4:7], v[188:191], v[212:215], v[4:7]
  v_mfma_f32_16x16x32_bf16 v[8:11], v[188:191], v[216:219], v[8:11]
  v_mfma_f32_16x16x32_bf16 v[12:15], v[188:191], v[220:223], v[12:15]
  v_mfma_f32_16x16x32_bf16 v[16:19], v[192:195], v[208:211], v[16:19]
  v_mfma_f32_16x16x32_bf16 v[20:23], v[192:195], v[212:215], v[20:23]
  v_mfma_f32_16x16x32_bf16 v[24:27], v[192:195], v[216:219], v[24:27]
  v_mfma_f32_16x16x32_bf16 v[28:31], v[192:195], v[220:223], v[28:31]
  v_mfma_f32_16x16x32_bf16 v[32:35], v[196:199], v[208:211], v[32:35]
  v_mfma_f32_16x16x32_bf16 v[36:39], v[196:199], v[212:215], v[36:39]
  v_mfma_f32_16x16x32_bf16 v[40:43], v[196:199], v[216:219], v[40:43]
  v_mfma_f32_16x16x32_bf16 v[44:47], v[196:199], v[220:223], v[44:47]
  v_mfma_f32_16x16x32_bf16 v[48:51], v[200:203], v[208:211], v[48:51]
  v_mfma_f32_16x16x32_bf16 v[52:55], v[200:203], v[212:215], v[52:55]
  v_mfma_f32_16x16x32_bf16 v[56:59], v[200:203], v[216:219], v[56:59]
  v_mfma_f32_16x16x32_bf16 v[60:63], v[200:203], v[220:223], v[60:63]
  v_mfma_f32_16x16x32_bf16 v[64:67], v[204:207], v[208:211], v[64:67]
  v_mfma_f32_16x16x32_bf16 v[68:71], v[204:207], v[212:215], v[68:71]
  v_mfma_f32_16x16x32_bf16 v[72:75], v[204:207], v[216:219], v[72:75]
  v_mfma_f32_16x16x32_bf16 v[76:79], v[204:207], v[220:223], v[76:79]
  s_nop 3
  v_add_u32 v230, s53, v225
  ds_write_b128 v230, v[4:7] offset:0
  ds_write_b128 v230, v[20:23] offset:1024
  ds_write_b128 v230, v[36:39] offset:2048
  ds_write_b128 v230, v[52:55] offset:3072
  ds_write_b128 v230, v[68:71] offset:4096
  v_add_u32 v230, s54, v225
  ds_write_b128 v230, v[8:11] offset:0
  ds_write_b128 v230, v[24:27] offset:1024
  ds_write_b128 v230, v[40:43] offset:2048
  ds_write_b128 v230, v[56:59] offset:3072
  ds_write_b128 v230, v[72:75] offset:4096
  v_add_u32 v230, s55, v225
  ds_write_b128 v230, v[12:15] offset:0
  ds_write_b128 v230, v[28:31] offset:1024
  ds_write_b128 v230, v[44:47] offset:2048
  ds_write_b128 v230, v[60:63] offset:3072
  ds_write_b128 v230, v[76:79] offset:4096
  s_waitcnt lgkmcnt(0)
  s_barrier
  ds_read_b128 v[100:103], v232 offset:0
  ds_read_b128 v[104:107], v232 offset:5120
  ds_read_b128 v[108:111], v232 offset:10240
  ds_read_b128 v[112:115], v232 offset:1024
  ds_read_b128 v[116:119], v232 offset:6144
  ds_read_b128 v[120:123], v232 offset:11264
  ds_read_b128 v[124:127], v232 offset:2048
  ds_read_b128 v[128:131], v232 offset:7168
  ds_read_b128 v[132:135], v232 offset:12288
  ds_read_b128 v[136:139], v232 offset:3072
  ds_read_b128 v[140:143], v232 offset:8192
  ds_read_b128 v[144:147], v232 offset:13312
  ds_read_b128 v[148:151], v232 offset:4096
  ds_read_b128 v[152:155], v232 offset:9216
  ds_read_b128 v[156:159], v232 offset:14336
  s_waitcnt lgkmcnt(12)
  v_pk_add_f32 v[0:1], v[0:1], v[100:101]
  v_pk_add_f32 v[104:105], v[104:105], v[108:109]
  v_pk_add_f32 v[2:3], v[2:3], v[102:103]
  v_pk_add_f32 v[106:107], v[106:107], v[110:111]
  v_pk_add_f32 v[0:1], v[0:1], v[104:105]
  v_pk_add_f32 v[2:3], v[2:3], v[106:107]
  v_cvt_pk_bf16_f32 v160, v0, v1
  v_cvt_pk_bf16_f32 v161, v2, v3
  v_lshlrev_b32 v162, 16, v160
  v_and_b32 v163, 0xffff0000, v160
  v_lshlrev_b32 v166, 16, v236
  v_and_b32 v167, 0xffff0000, v236
  v_lshlrev_b32 v164, 16, v161
  v_and_b32 v165, 0xffff0000, v161
  v_lshlrev_b32 v168, 16, v237
  v_and_b32 v169, 0xffff0000, v237
  v_pk_add_f32 v[162:163], v[162:163], v[166:167]
  v_pk_add_f32 v[164:165], v[164:165], v[168:169]
  v_cvt_pk_bf16_f32 v170, v162, v163
  v_cvt_pk_bf16_f32 v171, v164, v165
  buffer_store_dwordx2 v[170:171], v233, s[24:27], 0 offen offset:0
  s_waitcnt lgkmcnt(9)
  v_pk_add_f32 v[16:17], v[16:17], v[112:113]
  v_pk_add_f32 v[116:117], v[116:117], v[120:121]
  v_pk_add_f32 v[18:19], v[18:19], v[114:115]
  v_pk_add_f32 v[118:119], v[118:119], v[122:123]
  v_pk_add_f32 v[16:17], v[16:17], v[116:117]
  v_pk_add_f32 v[18:19], v[18:19], v[118:119]
  v_cvt_pk_bf16_f32 v172, v16, v17
  v_cvt_pk_bf16_f32 v173, v18, v19
  v_lshlrev_b32 v174, 16, v172
  v_and_b32 v175, 0xffff0000, v172
  v_lshlrev_b32 v178, 16, v238
  v_and_b32 v179, 0xffff0000, v238
  v_lshlrev_b32 v176, 16, v173
  v_and_b32 v177, 0xffff0000, v173
  v_lshlrev_b32 v180, 16, v239
  v_and_b32 v181, 0xffff0000, v239
  v_pk_add_f32 v[174:175], v[174:175], v[178:179]
  v_pk_add_f32 v[176:177], v[176:177], v[180:181]
  v_cvt_pk_bf16_f32 v182, v174, v175
  v_cvt_pk_bf16_f32 v183, v176, v177
  buffer_store_dwordx2 v[182:183], v233, s[24:27], 0 offen offset:32
  s_waitcnt lgkmcnt(6)
  v_pk_add_f32 v[32:33], v[32:33], v[124:125]
  v_pk_add_f32 v[128:129], v[128:129], v[132:133]
  v_pk_add_f32 v[34:35], v[34:35], v[126:127]
  v_pk_add_f32 v[130:131], v[130:131], v[134:135]
  v_pk_add_f32 v[32:33], v[32:33], v[128:129]
  v_pk_add_f32 v[34:35], v[34:35], v[130:131]
  v_cvt_pk_bf16_f32 v160, v32, v33
  v_cvt_pk_bf16_f32 v161, v34, v35
  v_lshlrev_b32 v162, 16, v160
  v_and_b32 v163, 0xffff0000, v160
  v_lshlrev_b32 v166, 16, v240
  v_and_b32 v167, 0xffff0000, v240
  v_lshlrev_b32 v164, 16, v161
  v_and_b32 v165, 0xffff0000, v161
  v_lshlrev_b32 v168, 16, v241
  v_and_b32 v169, 0xffff0000, v241
  v_pk_add_f32 v[162:163], v[162:163], v[166:167]
  v_pk_add_f32 v[164:165], v[164:165], v[168:169]
  v_cvt_pk_bf16_f32 v170, v162, v163
  v_cvt_pk_bf16_f32 v171, v164, v165
  buffer_store_dwordx2 v[170:171], v233, s[24:27], 0 offen offset:64
  s_waitcnt lgkmcnt(3)
  v_pk_add_f32 v[48:49], v[48:49], v[136:137]
  v_pk_add_f32 v[140:141], v[140:141], v[144:145]
  v_pk_add_f32 v[50:51], v[50:51], v[138:139]
  v_pk_add_f32 v[142:143], v[142:143], v[146:147]
  v_pk_add_f32 v[48:49], v[48:49], v[140:141]
  v_pk_add_f32 v[50:51], v[50:51], v[142:143]
  v_cvt_pk_bf16_f32 v172, v48, v49
  v_cvt_pk_bf16_f32 v173, v50, v51
  v_lshlrev_b32 v174, 16, v172
  v_and_b32 v175, 0xffff0000, v172
  v_lshlrev_b32 v178, 16, v242
  v_and_b32 v179, 0xffff0000, v242
  v_lshlrev_b32 v176, 16, v173
  v_and_b32 v177, 0xffff0000, v173
  v_lshlrev_b32 v180, 16, v243
  v_and_b32 v181, 0xffff0000, v243
  v_pk_add_f32 v[174:175], v[174:175], v[178:179]
  v_pk_add_f32 v[176:177], v[176:177], v[180:181]
  v_cvt_pk_bf16_f32 v182, v174, v175
  v_cvt_pk_bf16_f32 v183, v176, v177
  buffer_store_dwordx2 v[182:183], v233, s[24:27], 0 offen offset:96
  s_waitcnt lgkmcnt(0)
  v_pk_add_f32 v[64:65], v[64:65], v[148:149]
  v_pk_add_f32 v[152:153], v[152:153], v[156:157]
  v_pk_add_f32 v[66:67], v[66:67], v[150:151]
  v_pk_add_f32 v[154:155], v[154:155], v[158:159]
  v_pk_add_f32 v[64:65], v[64:65], v[152:153]
  v_pk_add_f32 v[66:67], v[66:67], v[154:155]
  v_cvt_pk_bf16_f32 v160, v64, v65
  v_cvt_pk_bf16_f32 v161, v66, v67
  v_lshlrev_b32 v162, 16, v160
  v_and_b32 v163, 0xffff0000, v160
  v_lshlrev_b32 v166, 16, v244
  v_and_b32 v167, 0xffff0000, v244
  v_lshlrev_b32 v164, 16, v161
  v_and_b32 v165, 0xffff0000, v161
  v_lshlrev_b32 v168, 16, v245
  v_and_b32 v169, 0xffff0000, v245
  v_pk_add_f32 v[162:163], v[162:163], v[166:167]
  v_pk_add_f32 v[164:165], v[164:165], v[168:169]
  v_cvt_pk_bf16_f32 v170, v162, v163
  v_cvt_pk_bf16_f32 v171, v164, v165
  buffer_store_dwordx2 v[170:171], v234, s[24:27], 0 offen offset:128
gemm12_kernel_fin:
gemm12_kernel_end:
  s_endpgm
all_code_end:
.section .rodata,"a"
.p2align 6
.amdhsa_kernel gemm12_kernel
  .amdhsa_next_free_vgpr 256
  .amdhsa_next_free_sgpr 102
  .amdhsa_accum_offset 256
  .amdhsa_group_segment_fixed_size 0
  .amdhsa_kernarg_size 112
  .amdhsa_user_sgpr_count 2
  .amdhsa_user_sgpr_kernarg_segment_ptr 1
  .amdhsa_system_sgpr_workgroup_id_x 1
  .amdhsa_float_denorm_mode_32 3
  .amdhsa_float_denorm_mode_16_64 3
.end_amdhsa_kernel
.text
```
